```python
import torch

def _softmax(x, axis=-1):
    return torch.softmax(x, dim=axis)
def _gelu(x):
    return torch.nn.functional.gelu(x, approximate="tanh")
def _silu(x):
    return torch.nn.functional.silu(x)
def _sigmoid(x):
    return torch.sigmoid(x)
def _layernorm(x, axis=-1, eps=1e-5):
    m = x.mean(dim=axis, keepdim=True)
    v = x.var(dim=axis, keepdim=True, unbiased=False)
    return (x - m) / torch.sqrt(v + eps)
def _scatter_add(tgt, idx, src, axis=0):
    return tgt.clone().index_add_(axis, idx, src)
def _segment_sum(src, seg, n):
    out = torch.zeros((n,) + src.shape[1:], dtype=src.dtype)
    return out.index_add_(0, seg, src)
def _pad(x, pw):
    flat = tuple(v for pair in reversed(pw) for v in pair)
    return torch.nn.functional.pad(x, flat)

kernel_name = 'gated_mix__spectral_fnet__sliding_local_dilated__prompt'

def setup_inputs():

    _w = (lambda a: (lambda t: t.to(torch.bfloat16) if t.is_floating_point() else t)(torch.as_tensor(a)))
    def _A_setup():
        B, S, D = 1, 2048, 448
        ns = torch.arange(S)[:, None] * torch.arange(S)[None, :]
        nd = torch.arange(D)[:, None] * torch.arange(D)[None, :]
        Ws_re = torch.cos(-2.0 * torch.pi * ns / S).to(float)
        Ws_im = torch.sin(-2.0 * torch.pi * ns / S).to(float)
        Wd_re = torch.cos(-2.0 * torch.pi * nd / D).to(float)
        Wd_im = torch.sin(-2.0 * torch.pi * nd / D).to(float)
        return {
            "x": _w((lambda *s: torch.randn(*s, dtype=torch.bfloat16) * 0.05)(B, S, D)),
            "dft_seq_re": _w(Ws_re),
            "dft_seq_im": _w(Ws_im),
            "dft_hid_re": _w(Wd_re),
            "dft_hid_im": _w(Wd_im),
        }
    _A_in = _A_setup()

    def _B_setup():
        B, S, D = 1, 2048, 448
        return {
            "x": _w((lambda *s: torch.randn(*s, dtype=torch.bfloat16) * 0.05)(B, S, D)),
            "wqkv": _w((lambda *s: torch.randn(*s, dtype=torch.bfloat16) * 1.6)(D, 3 * D)),
            "wo": _w((lambda *s: torch.randn(*s, dtype=torch.bfloat16) * 0.2)(D, D)),
        }
    _B_in = _B_setup()

    return {
        "A_x": _A_in["x"],
        "A_dft_seq_re": _A_in["dft_seq_re"],
        "A_dft_seq_im": _A_in["dft_seq_im"],
        "A_dft_hid_re": _A_in["dft_hid_re"],
        "A_dft_hid_im": _A_in["dft_hid_im"],
        "B_x": _B_in["x"],
        "B_wqkv": _B_in["wqkv"],
        "B_wo": _B_in["wo"],
        "gate_w": _w((lambda *s: torch.randn(*s, dtype=torch.bfloat16) * 0.05)(448) * 16.0),
    }

def reference(A_x, A_dft_seq_re, A_dft_seq_im, A_dft_hid_re, A_dft_hid_im, B_x, B_wqkv, B_wo, gate_w):
    def _A_ref(x, dft_seq_re, dft_seq_im, dft_hid_re, dft_hid_im):
        a = torch.einsum("bsd,ed->bse", x, dft_hid_re)
        b = torch.einsum("bsd,ed->bse", x, dft_hid_im)
        y = torch.einsum("ts,bse->bte", dft_seq_re, a) - torch.einsum("ts,bse->bte", dft_seq_im, b)
        return y

    def _B_ref(x, wqkv, wo):
        B, S, D = x.shape
        H = 16; Dh = D // H
        W, dil = 8, 2
        qkv = (lambda x, *d: x.permute(*d))((x @ wqkv).reshape(B, S, 3, H, Dh), 2, 0, 3, 1, 4)
        q, k, v = qkv[0], qkv[1], qkv[2]
        scale = Dh ** -0.5
        pos = torch.arange(S)
        off = torch.arange(W) * dil
        idx = pos[:, None] - off[None, :]
        mask = idx >= 0
        idx_c = torch.where(mask, idx, 0).reshape(-1)
        kg = k[:, :, idx_c, :].reshape(B, H, S, W, Dh)
        vg = v[:, :, idx_c, :].reshape(B, H, S, W, Dh)
        logits = torch.einsum("bhsd,bhswd->bhsw", q, kg) * scale
        logits = torch.where(mask[None, None, :, :], logits, -1e9)
        attn = _softmax(logits, axis=-1)
        o = torch.einsum("bhsw,bhswd->bhsd", attn, vg)
        return (lambda x, *d: x.permute(*d))(o, 0, 2, 1, 3).reshape(B, S, D) @ wo

    x = A_x
    g = _sigmoid((x * gate_w).sum(-1, keepdims=True))
    a = _A_ref(x, A_dft_seq_re, A_dft_seq_im, A_dft_hid_re, A_dft_hid_im)
    b = _B_ref(x, B_wqkv, B_wo)
    return g * a + (1 - g) * b
```

```asm
; @launch kernel=fnet_k1_kernel grid=(240,1,1) block=(512,1,1) lds=156672
; @launch kernel=fnet_k2_kernel grid=(232,1,1) block=(512,1,1) lds=147456
.amdgcn_target "amdgcn-amd-amdhsa--gfx950"
.text
.globl fnet_k1_kernel
.p2align 8
.type fnet_k1_kernel,@function
fnet_k1_kernel:
    s_cmp_ge_u32 s2, 240
    s_cbranch_scc1 K1_end
    s_load_dwordx2 s[92:93], s[0:1], 0
    s_load_dwordx2 s[94:95], s[0:1], 48
    s_load_dwordx2 s[90:91], s[0:1], 88
    s_load_dwordx4 s[60:63], s[0:1], 56
    s_and_b32 s25, s2, 7
    s_lshr_b32 s26, s2, 3
    v_lshrrev_b32 v1, 6, v0
    v_and_b32 v0, 63, v0
    v_readfirstlane_b32 s24, v1
    v_and_b32 v2, 15, v0
    v_lshrrev_b32 v3, 4, v0
    v_lshrrev_b32 v4, 3, v0
    v_and_b32 v5, 7, v0
    s_cmp_ge_u32 s26, 22
    s_cbranch_scc1 K1_spec
    s_lshr_b32 s27, s25, 1
    s_mul_i32 s27, s27, 22
    s_add_u32 s27, s27, s26
    s_and_b32 s28, s27, 3
    s_lshr_b32 s27, s27, 2
    s_and_b32 s30, s25, 1
    s_lshl_b32 s30, s30, 2
    s_add_u32 s28, s28, s30
    s_mul_i32 s29, s27, 96
    s_and_b32 s23, s24, 3
    s_and_b32 s30, s23, 1
    s_lshr_b32 s31, s23, 1
    s_cmp_lt_u32 s24, 4
    s_cbranch_scc0 K1_ld
    s_mov_b64 exec, 0
    s_cmp_lt_u32 s26, 14
    s_cselect_b32 s40, 0, 4
    s_add_u32 s40, s40, s24
    s_cmp_eq_u32 s40, 0
    s_cbranch_scc1 K1_lad0
    s_cmp_eq_u32 s40, 1
    s_cbranch_scc1 K1_lad1
    s_cmp_eq_u32 s40, 2
    s_cbranch_scc1 K1_lad2
    s_cmp_eq_u32 s40, 3
    s_cbranch_scc1 K1_lad3
    s_cmp_eq_u32 s40, 4
    s_cbranch_scc1 K1_hop85
    s_cmp_eq_u32 s40, 5
    s_cbranch_scc1 K1_hop108
    s_cmp_eq_u32 s40, 6
    s_cbranch_scc1 K1_hop130
    s_branch K1_hop155
    s_nop 0
K1_ld:
    s_lshl_b32 s32, s30, 2
    v_add_u32 v6, s32, v3
    v_xor_b32 v6, v5, v6
    v_and_b32 v6, 7, v6
    v_lshlrev_b32 v6, 4, v6
    s_lshl_b32 s32, s23, 3
    s_add_u32 s32, s32, s29
    s_sub_u32 s32, s32, 16
    s_movk_i32 s33, 896
    s_movk_i32 s34, 2047
    v_add_u32 v7, s32, v4
    v_add_u32 v7, 0, v7
    v_med3_i32 v7, v7, 0, s34
    v_mad_u32_u24 v8, v7, s33, v6
    v_add_u32 v7, s32, v4
    v_add_u32 v7, 32, v7
    v_med3_i32 v7, v7, 0, s34
    v_mad_u32_u24 v9, v7, s33, v6
    v_add_u32 v7, s32, v4
    v_add_u32 v7, 64, v7
    v_med3_i32 v7, v7, 0, s34
    v_mad_u32_u24 v10, v7, s33, v6
    v_add_u32 v7, s32, v4
    v_add_u32 v7, 96, v7
    v_med3_i32 v7, v7, 0, s34
    v_mad_u32_u24 v11, v7, s33, v6
    v_and_b32 v6, 1, v3
    v_lshlrev_b32 v6, 1, v6
    s_lshl_b32 s32, s30, 2
    v_add_u32 v6, s32, v6
    v_xor_b32 v6, v5, v6
    v_min_u32 v6, 6, v6
    v_lshlrev_b32 v6, 4, v6
    s_mul_i32 s32, s28, 112
    v_add_u32 v6, s32, v6
    s_lshl_b32 s32, s23, 3
    v_add_u32 v7, s32, v4
    s_movk_i32 s33, 2688
    v_mad_u32_u24 v12, v7, s33, v6
    v_add_u32 v13, 86016, v12
    s_lshl_b32 s35, s23, 10
    s_waitcnt lgkmcnt(0)
    s_mov_b32 s4, s92
    s_mov_b32 s5, s93
    s_mov_b32 s6, 0x1c0000
    s_mov_b32 s7, 0x20000
    s_mov_b32 s8, s94
    s_mov_b32 s9, s95
    s_mov_b32 s10, 0x126000
    s_mov_b32 s11, 0x20000
    s_mov_b32 s40, s62
    s_mov_b32 s41, s63
    s_mov_b32 s42, 0x380
    s_mov_b32 s43, 0x20000
K1_hop85:
    s_cbranch_execz K1_ret
    s_add_u32 s44, s90, 0x300000
    s_addc_u32 s45, s91, 0
    s_mov_b32 s46, 0x2000
    s_mov_b32 s47, 0x20000
    s_cmp_lt_u32 s28, 6
    s_cselect_b32 s39, s23, 0
    s_cmp_lg_u32 s39, 3
    s_cbranch_scc1 K1_g0
    v_lshlrev_b32 v6, 4, v0
    s_mov_b32 m0, 155648
    v_mov_b32 v16, 0
    buffer_load_dwordx4 v6, s[40:43], 0 offen lds
    v_mov_b32 v17, 0
    v_mov_b32 v18, 0
    v_mov_b32 v19, 0
    v_lshrrev_b32 v6, 1, v2
    v_xor_b32 v6, v3, v6
    v_lshlrev_b32 v6, 4, v6
    v_lshl_add_u32 v6, v2, 7, v6
    s_lshl_b32 s32, s28, 11
    s_add_u32 s32, s32, 2048
    v_add_u32 v20, s32, v6
    v_lshlrev_b32 v22, 4, v3
K1_hop108:
    s_cbranch_execz K1_ret
    v_add_u32 v22, 155648, v22
K1_g0:
    s_mov_b32 s36, 0
    s_mov_b32 s37, 0
    s_mov_b32 s38, s35
K1_loop0:
    s_add_u32 m0, s38, 21632
    s_nop 0
    buffer_load_dwordx4 v12, s[8:11], s36 offen offset:896 lds
    s_add_u32 m0, s38, 14336
    s_nop 0
    buffer_load_dwordx4 v12, s[8:11], s36 offen offset:0 lds
    s_add_u32 m0, s38, 28928
    s_nop 0
    buffer_load_dwordx4 v12, s[8:11], s36 offen offset:1792 lds
    s_add_u32 m0, s38, 0
    s_nop 0
    buffer_load_dwordx4 v8, s[4:7], s37 offen lds
    s_add_u32 m0, s38, 4096
    s_nop 0
    buffer_load_dwordx4 v9, s[4:7], s37 offen lds
    s_add_u32 m0, s38, 8192
K1_hop130:
    s_cbranch_execz K1_ret
    s_nop 0
    buffer_load_dwordx4 v10, s[4:7], s37 offen lds
    s_cmp_eq_u32 s37, 0
    s_cbranch_scc1 K1_nb
    s_waitcnt vmcnt(6)
    s_barrier
    s_cmp_lg_u32 s39, 3
    s_cbranch_scc1 K1_g10
    v_add_u32 v6, s48, v20
    v_xor_b32 v7, 64, v6
    ds_read_b128 v[24:27], v6
    ds_read_b128 v[32:35], v22
    ds_read_b128 v[28:31], v7
    ds_read_b128 v[36:39], v22 offset:64
    v_add_u32 v22, 128, v22
K1_g10:
K1_nb:
    s_cmp_ge_u32 s23, 2
    s_cbranch_scc1 K1_sk0
    s_add_u32 m0, s38, 12288
    s_nop 0
    buffer_load_dwordx4 v11, s[4:7], s37 offen lds
K1_sk0:
    s_add_u32 m0, s38, 25728
    s_nop 0
K1_hop155:
    s_cbranch_execz K1_ret
    buffer_load_dwordx4 v13, s[8:11], s36 offen offset:896 lds
    s_add_u32 m0, s38, 18432
    s_nop 0
    buffer_load_dwordx4 v13, s[8:11], s36 offen offset:0 lds
    s_add_u32 m0, s38, 33024
    s_nop 0
    buffer_load_dwordx4 v13, s[8:11], s36 offen offset:1792 lds
    s_cmp_eq_u32 s37, 0
    s_cselect_b32 s32, 0, s39
    s_cmp_lg_u32 s32, 3
    s_cbranch_scc1 K1_g20
    s_waitcnt lgkmcnt(0)
    v_mfma_f32_16x16x32_bf16 v[16:19], v[24:27], v[32:35], v[16:19]
    v_mfma_f32_16x16x32_bf16 v[16:19], v[28:31], v[36:39], v[16:19]
K1_g20:
    s_sub_u32 s48, s38, s35
    s_add_u32 s36, s36, 172032
    s_add_u32 s37, s37, 128
    s_add_u32 s38, s38, 38912
    s_cmp_eq_u32 s37, 512
    s_cselect_b32 s38, s35, s38
    s_cmp_lt_u32 s37, 640
    s_cbranch_scc1 K1_loop0
K1_loop1:
    s_add_u32 m0, s38, 21632
    s_nop 0
    buffer_load_dwordx4 v12, s[8:11], s36 offen offset:896 lds
    s_add_u32 m0, s38, 14336
    s_nop 0
    buffer_load_dwordx4 v12, s[8:11], s36 offen offset:0 lds
    s_add_u32 m0, s38, 0
    s_nop 0
    buffer_load_dwordx4 v8, s[4:7], s37 offen lds
    s_add_u32 m0, s38, 4096
    s_nop 0
    buffer_load_dwordx4 v9, s[4:7], s37 offen lds
    s_add_u32 m0, s38, 8192
    s_nop 0
    buffer_load_dwordx4 v10, s[4:7], s37 offen lds
    s_waitcnt vmcnt(5)
    s_barrier
    s_cmp_lg_u32 s39, 3
    s_cbranch_scc1 K1_g11
    v_add_u32 v6, s48, v20
    v_xor_b32 v7, 64, v6
    ds_read_b128 v[24:27], v6
    ds_read_b128 v[32:35], v22
    ds_read_b128 v[28:31], v7
    ds_read_b128 v[36:39], v22 offset:64
    v_add_u32 v22, 128, v22
K1_g11:
    s_cmp_ge_u32 s23, 2
    s_cbranch_scc1 K1_sk1
    s_add_u32 m0, s38, 12288
    s_nop 0
    buffer_load_dwordx4 v11, s[4:7], s37 offen lds
K1_sk1:
    s_add_u32 m0, s38, 25728
    s_nop 0
    buffer_load_dwordx4 v13, s[8:11], s36 offen offset:896 lds
    s_add_u32 m0, s38, 18432
    s_nop 0
    buffer_load_dwordx4 v13, s[8:11], s36 offen offset:0 lds
    s_cmp_eq_u32 s37, 0
    s_cselect_b32 s32, 0, s39
    s_cmp_lg_u32 s32, 3
    s_cbranch_scc1 K1_g21
    s_waitcnt lgkmcnt(0)
    v_mfma_f32_16x16x32_bf16 v[16:19], v[24:27], v[32:35], v[16:19]
    v_mfma_f32_16x16x32_bf16 v[16:19], v[28:31], v[36:39], v[16:19]
K1_g21:
    s_sub_u32 s48, s38, s35
    s_add_u32 s36, s36, 172032
    s_add_u32 s37, s37, 128
    s_add_u32 s38, s38, 38912
    s_cmp_eq_u32 s37, 512
    s_cselect_b32 s38, s35, s38
    s_cmp_lt_u32 s37, 896
    s_cbranch_scc1 K1_loop1
    s_mov_b32 s36, 860160
    s_add_u32 m0, s35, 67840
    s_nop 0
    buffer_load_dwordx4 v12, s[8:11], s36 offen offset:1792 lds
    s_add_u32 m0, s35, 71936
    s_nop 0
    buffer_load_dwordx4 v13, s[8:11], s36 offen offset:1792 lds
    s_waitcnt vmcnt(4)
    s_barrier
    s_mov_b32 s36, 1032192
    s_add_u32 m0, s35, 106752
    s_nop 0
    buffer_load_dwordx4 v12, s[8:11], s36 offen offset:1792 lds
    s_add_u32 m0, s35, 110848
    s_nop 0
    buffer_load_dwordx4 v13, s[8:11], s36 offen offset:1792 lds
    s_waitcnt vmcnt(4)
    s_barrier
    s_waitcnt vmcnt(2)
    s_barrier
    s_waitcnt vmcnt(0)
    s_barrier
    s_cmp_lg_u32 s39, 3
    s_cbranch_scc1 K1_g12
    v_add_u32 v6, s48, v20
    v_xor_b32 v7, 64, v6
    ds_read_b128 v[24:27], v6
    ds_read_b128 v[32:35], v22
    ds_read_b128 v[28:31], v7
    ds_read_b128 v[36:39], v22 offset:64
    v_add_u32 v22, 128, v22
K1_g12:
    s_cmp_lg_u32 s39, 3
    s_cbranch_scc1 K1_g3
    s_waitcnt lgkmcnt(0)
    v_mfma_f32_16x16x32_bf16 v[16:19], v[24:27], v[32:35], v[16:19]
    v_mfma_f32_16x16x32_bf16 v[16:19], v[28:31], v[36:39], v[16:19]
    s_lshl_b32 s32, s28, 4
    s_add_u32 s32, s32, s29
    s_lshl_b32 s32, s32, 2
    v_lshlrev_b32 v6, 4, v3
    v_add_u32 v6, s32, v6
    v_mov_b32 v7, 0x80000000
    v_cmp_eq_u32 vcc, 0, v2
    s_nop 1
    v_cndmask_b32 v6, v7, v6, vcc
    v_cvt_pk_bf16_f32 v16, v16, v16
    v_cvt_pk_bf16_f32 v17, v17, v17
    v_cvt_pk_bf16_f32 v18, v18, v18
    v_cvt_pk_bf16_f32 v19, v19, v19
    v_lshlrev_b32 v16, 16, v16
    v_lshlrev_b32 v17, 16, v17
    v_lshlrev_b32 v18, 16, v18
    v_lshlrev_b32 v19, 16, v19
    v_mul_f32 v16, 0xbfb8aa3b, v16
    v_mul_f32 v17, 0xbfb8aa3b, v17
    v_mul_f32 v18, 0xbfb8aa3b, v18
    v_mul_f32 v19, 0xbfb8aa3b, v19
    v_exp_f32 v16, v16
    v_exp_f32 v17, v17
    v_exp_f32 v18, v18
    v_exp_f32 v19, v19
    v_add_f32 v16, 1.0, v16
    v_add_f32 v17, 1.0, v17
    v_add_f32 v18, 1.0, v18
    v_add_f32 v19, 1.0, v19
    v_rcp_f32 v16, v16
    v_rcp_f32 v17, v17
    v_rcp_f32 v18, v18
    v_rcp_f32 v19, v19
    v_cvt_pk_bf16_f32 v16, v16, v16
    v_cvt_pk_bf16_f32 v17, v17, v17
    v_cvt_pk_bf16_f32 v18, v18, v18
    v_cvt_pk_bf16_f32 v19, v19, v19
    v_lshlrev_b32 v16, 16, v16
    v_lshlrev_b32 v17, 16, v17
    v_lshlrev_b32 v18, 16, v18
    v_lshlrev_b32 v19, 16, v19
    v_sub_f32 v24, 1.0, v16
    v_sub_f32 v25, 1.0, v17
    v_sub_f32 v26, 1.0, v18
    v_sub_f32 v27, 1.0, v19
    v_cvt_pk_bf16_f32 v16, v16, v24
    v_cvt_pk_bf16_f32 v17, v17, v25
    v_cvt_pk_bf16_f32 v18, v18, v26
    v_cvt_pk_bf16_f32 v19, v19, v27
    buffer_store_dwordx4 v[16:19], v6, s[44:47], 0 offen
K1_g3:
    s_mov_b64 exec, 0
    s_and_b32 s23, s24, 3
    s_cmp_eq_u32 s23, 0
    s_cbranch_scc1 K2_seg0
    s_cmp_eq_u32 s23, 1
    s_cbranch_scc1 K2_seg1
    s_cmp_eq_u32 s23, 2
    s_cbranch_scc1 K2_seg2
    s_branch K2_seg3
K1_comp:
.p2align 7
K1_lad0:
    s_cmp_eq_u32 s26, 0
    s_cbranch_scc1 K1_hop353
    s_cmp_eq_u32 s26, 1
    s_cbranch_scc1 K1_hop436
    s_cmp_eq_u32 s26, 2
    s_cbranch_scc1 K1_hop509
    s_cmp_eq_u32 s26, 3
    s_cbranch_scc1 K1_hop577
    s_cmp_eq_u32 s26, 4
    s_cbranch_scc1 K1_hop645
    s_cmp_eq_u32 s26, 5
    s_cbranch_scc1 K1_hop713
    s_cmp_eq_u32 s26, 6
    s_cbranch_scc1 K1_hop780
    s_cmp_eq_u32 s26, 7
    s_cbranch_scc1 K1_hop848
    s_cmp_eq_u32 s26, 8
    s_cbranch_scc1 K1_hop915
    s_cmp_eq_u32 s26, 9
    s_cbranch_scc1 K1_hop986
    s_cmp_eq_u32 s26, 10
    s_cbranch_scc1 K1_hop1055
    s_cmp_eq_u32 s26, 11
    s_cbranch_scc1 K1_hop1120
    s_cmp_eq_u32 s26, 12
    s_cbranch_scc1 K1_hop1198
    s_cmp_eq_u32 s26, 13
    s_cbranch_scc1 K1_hop1279
    s_branch K1_ret
.p2align 7
K1_lad1:
    s_cmp_eq_u32 s26, 0
    s_cbranch_scc1 K1_hop374
    s_cmp_eq_u32 s26, 1
    s_cbranch_scc1 K1_hop460
    s_cmp_eq_u32 s26, 2
    s_cbranch_scc1 K1_hop527
    s_cmp_eq_u32 s26, 3
    s_cbranch_scc1 K1_hop594
    s_cmp_eq_u32 s26, 4
    s_cbranch_scc1 K1_hop661
    s_cmp_eq_u32 s26, 5
    s_cbranch_scc1 K1_hop730
    s_cmp_eq_u32 s26, 6
    s_cbranch_scc1 K1_hop797
    s_cmp_eq_u32 s26, 7
    s_cbranch_scc1 K1_hop865
    s_cmp_eq_u32 s26, 8
    s_cbranch_scc1 K1_hop933
    s_cmp_eq_u32 s26, 9
    s_cbranch_scc1 K1_hop1003
    s_cmp_eq_u32 s26, 10
    s_cbranch_scc1 K1_hop1071
    s_cmp_eq_u32 s26, 11
    s_cbranch_scc1 K1_hop1142
    s_cmp_eq_u32 s26, 12
    s_cbranch_scc1 K1_hop1219
    s_cmp_eq_u32 s26, 13
    s_cbranch_scc1 K1_hop1296
    s_branch K1_ret
.p2align 7
K1_lad2:
    s_cmp_eq_u32 s26, 0
    s_cbranch_scc1 K1_hop395
    s_cmp_eq_u32 s26, 1
    s_cbranch_scc1 K1_hop475
    s_cmp_eq_u32 s26, 2
    s_cbranch_scc1 K1_hop544
    s_cmp_eq_u32 s26, 3
    s_cbranch_scc1 K1_hop610
    s_cmp_eq_u32 s26, 4
    s_cbranch_scc1 K1_hop679
    s_cmp_eq_u32 s26, 5
    s_cbranch_scc1 K1_hop746
    s_cmp_eq_u32 s26, 6
    s_cbranch_scc1 K1_hop814
    s_cmp_eq_u32 s26, 7
    s_cbranch_scc1 K1_hop881
    s_cmp_eq_u32 s26, 8
    s_cbranch_scc1 K1_hop950
    s_cmp_eq_u32 s26, 9
    s_cbranch_scc1 K1_hop1021
    s_cmp_eq_u32 s26, 10
    s_cbranch_scc1 K1_hop1087
    s_cmp_eq_u32 s26, 11
    s_cbranch_scc1 K1_hop1166
    s_cmp_eq_u32 s26, 12
    s_cbranch_scc1 K1_hop1239
    s_cmp_eq_u32 s26, 13
    s_cbranch_scc1 K1_hop1316
    s_branch K1_ret
.p2align 7
K1_lad3:
    s_cmp_eq_u32 s26, 0
    s_cbranch_scc1 K1_hop415
    s_cmp_eq_u32 s26, 1
    s_cbranch_scc1 K1_hop493
    s_cmp_eq_u32 s26, 2
    s_cbranch_scc1 K1_hop560
    s_cmp_eq_u32 s26, 3
    s_cbranch_scc1 K1_hop628
    s_cmp_eq_u32 s26, 4
    s_cbranch_scc1 K1_hop695
    s_cmp_eq_u32 s26, 5
    s_cbranch_scc1 K1_hop763
    s_cmp_eq_u32 s26, 6
    s_cbranch_scc1 K1_hop830
    s_cmp_eq_u32 s26, 7
    s_cbranch_scc1 K1_hop898
    s_cmp_eq_u32 s26, 8
    s_cbranch_scc1 K1_hop968
    s_cmp_eq_u32 s26, 9
    s_cbranch_scc1 K1_hop1038
    s_cmp_eq_u32 s26, 10
    s_cbranch_scc1 K1_hop1103
    s_cmp_eq_u32 s26, 11
    s_cbranch_scc1 K1_hop1182
    s_cmp_eq_u32 s26, 12
    s_cbranch_scc1 K1_hop1260
    s_cmp_eq_u32 s26, 13
    s_cbranch_scc1 K1_hop1339
    s_branch K1_ret
.p2align 7
K1_ret:
    s_mov_b64 exec, -1
    v_lshrrev_b32 v6, 1, v2
    v_xor_b32 v6, v3, v6
    v_lshlrev_b32 v6, 4, v6
    v_lshl_add_u32 v6, v2, 7, v6
    s_mul_i32 s32, s31, 6144
    v_add_u32 v6, s32, v6
    v_xor_b32 v7, 64, v6
    v_add_u32 v14, 0, v6
    v_add_u32 v15, 0, v7
    v_add_u32 v16, 38912, v6
    v_add_u32 v17, 38912, v7
    v_add_u32 v18, 77824, v6
    v_add_u32 v19, 77824, v7
    v_add_u32 v20, 116736, v6
    v_add_u32 v21, 116736, v7
    v_bfe_u32 v6, v0, 2, 2
    v_lshl_add_u32 v7, v3, 3, v6
    v_lshlrev_b32 v7, 7, v7
    v_and_b32 v6, 2, v6
    v_and_b32 v30, 1, v3
    v_lshl_add_u32 v6, v30, 2, v6
K1_hop353:
    s_cbranch_execz K1_ret
    v_lshlrev_b32 v6, 4, v6
    v_and_b32 v30, 3, v0
    v_lshlrev_b32 v30, 3, v30
    s_mul_i32 s32, s30, 56
    v_add_u32 v30, s32, v30
    v_add_u32 v31, 32, v30
    v_xor_b32 v30, v30, v6
    v_xor_b32 v31, v31, v6
    v_add_u32 v30, v30, v7
    v_add_u32 v31, v31, v7
    v_add_u32 v22, 14336, v30
    v_add_u32 v23, 14336, v31
    v_add_u32 v24, 53248, v30
    v_add_u32 v25, 53248, v31
    v_add_u32 v26, 92160, v30
    v_add_u32 v27, 92160, v31
    v_add_u32 v28, 131072, v30
    v_add_u32 v29, 131072, v31
    v_mov_b32 v8, 0xf149f2ca
    v_lshlrev_b32 v6, 2, v3
    v_sub_u32 v9, v2, v6
K1_hop374:
    s_cbranch_execz K1_ret
    v_subrev_u32 v6, 0, v9
    v_add_u32 v7, 16, v6
    v_and_b32 v6, 0xfffffff1, v6
    v_and_b32 v7, 0xfffffff1, v7
    v_cmp_eq_u32 s[40:41], 0, v6
    v_cmp_eq_u32 s[42:43], 0, v7
    v_mov_b32 v212, 0x3f803f80
    v_cndmask_b32 v204, v8, 0, s[40:41]
    v_cndmask_b32 v200, v8, 0, s[42:43]
    v_subrev_u32 v6, 1, v9
    v_add_u32 v7, 16, v6
    v_and_b32 v6, 0xfffffff1, v6
    v_and_b32 v7, 0xfffffff1, v7
    v_cmp_eq_u32 s[40:41], 0, v6
    v_cmp_eq_u32 s[42:43], 0, v7
    v_mov_b32 v213, 0x3f803f80
    v_cndmask_b32 v205, v8, 0, s[40:41]
    v_cndmask_b32 v201, v8, 0, s[42:43]
    v_subrev_u32 v6, 2, v9
    v_add_u32 v7, 16, v6
    v_and_b32 v6, 0xfffffff1, v6
K1_hop395:
    s_cbranch_execz K1_ret
    v_and_b32 v7, 0xfffffff1, v7
    v_cmp_eq_u32 s[40:41], 0, v6
    v_cmp_eq_u32 s[42:43], 0, v7
    v_mov_b32 v214, 0x3f803f80
    v_cndmask_b32 v206, v8, 0, s[40:41]
    v_cndmask_b32 v202, v8, 0, s[42:43]
    v_subrev_u32 v6, 3, v9
    v_add_u32 v7, 16, v6
    v_and_b32 v6, 0xfffffff1, v6
    v_and_b32 v7, 0xfffffff1, v7
    v_cmp_eq_u32 s[40:41], 0, v6
    v_cmp_eq_u32 s[42:43], 0, v7
    v_mov_b32 v215, 0x3f803f80
    v_cndmask_b32 v207, v8, 0, s[40:41]
    v_cndmask_b32 v203, v8, 0, s[42:43]
    s_add_u32 s32, s27, s31
    s_cmp_eq_u32 s32, 0
    s_cselect_b64 s[40:41], 0, -1
    v_cndmask_b32 v208, v8, v200, s[40:41]
    v_cndmask_b32 v209, v8, v201, s[40:41]
K1_hop415:
    s_cbranch_execz K1_ret
    v_cndmask_b32 v210, v8, v202, s[40:41]
    v_cndmask_b32 v211, v8, v203, s[40:41]
    v_cmp_ne_u32 s[38:39], 3, v3
    s_mul_i32 s32, s31, 48
    s_add_u32 s32, s32, s29
    v_add_u32 v6, s32, v2
    s_movk_i32 s33, 896
    s_mul_i32 s32, s28, 112
    s_mul_i32 s34, s30, 56
    s_add_u32 s32, s32, s34
    v_lshlrev_b32 v7, 3, v3
    v_add_u32 v7, s32, v7
    v_mad_u32_u24 v30, v6, s33, v7
    v_mov_b32 v7, 0x80000000
    v_cndmask_b32 v31, v7, v30, s[38:39]
    v_and_b32 v6, 1, v3
    v_mul_u32_u24 v6, 24, v6
    v_add_u32 v6, v30, v6
    v_cndmask_b32 v12, v7, v6, s[38:39]
    v_cndmask_b32 v13, v6, v7, s[38:39]
    s_waitcnt lgkmcnt(0)
K1_hop436:
    s_cbranch_execz K1_ret
    s_mov_b32 s12, s90
    s_mov_b32 s13, s91
    s_mov_b32 s14, 0x200000
    s_mov_b32 s15, 0x20000
    s_mul_i32 s44, s31, 48
    s_add_u32 s44, s44, s29
    s_add_u32 s44, s44, 0
    s_lshr_b32 s44, s44, 6
    s_mul_i32 s44, s44, 128
    s_add_u32 s45, s44, 0
    s_mul_i32 s44, s31, 48
    s_add_u32 s44, s44, s29
    s_add_u32 s44, s44, 16
    s_lshr_b32 s44, s44, 6
    s_mul_i32 s44, s44, 128
    s_add_u32 s46, s44, 14336
    s_mul_i32 s44, s31, 48
    s_add_u32 s44, s44, s29
    s_add_u32 s44, s44, 32
    s_lshr_b32 s44, s44, 6
    s_mul_i32 s44, s44, 128
    s_add_u32 s47, s44, 28672
    s_barrier
    ds_read_b128 v[32:35], v14 offset:0
K1_hop460:
    s_cbranch_execz K1_ret
    ds_read_b64_tr_b16 v[72:73], v22 offset:8192
    ds_read_b64_tr_b16 v[74:75], v22 offset:8704
    ds_read_b64_tr_b16 v[76:77], v23 offset:8192
    ds_read_b64_tr_b16 v[78:79], v23 offset:8704
    ds_read_b128 v[36:39], v14 offset:2048
    ds_read_b128 v[40:43], v14 offset:4096
    ds_read_b128 v[44:47], v14 offset:6144
    ds_read_b64_tr_b16 v[64:65], v22 offset:0
    ds_read_b64_tr_b16 v[66:67], v22 offset:512
    ds_read_b64_tr_b16 v[68:69], v23 offset:0
    ds_read_b64_tr_b16 v[70:71], v23 offset:512
    ds_read_b64_tr_b16 v[80:81], v22 offset:16384
    ds_read_b64_tr_b16 v[82:83], v22 offset:16896
    ds_read_b64_tr_b16 v[84:85], v23 offset:16384
    ds_read_b64_tr_b16 v[86:87], v23 offset:16896
K1_hop475:
    s_cbranch_execz K1_ret
    s_waitcnt lgkmcnt(13)
    v_mfma_f32_16x16x32_bf16 v[136:139], v[72:75], v[32:35], 0
    ds_read_b128 v[48:51], v15 offset:0
    ds_read_b64_tr_b16 v[96:97], v22 offset:12288
    s_waitcnt lgkmcnt(13)
    v_mfma_f32_16x16x32_bf16 v[140:143], v[76:79], v[32:35], 0
    ds_read_b64_tr_b16 v[98:99], v22 offset:12800
    s_waitcnt lgkmcnt(13)
    v_mfma_f32_16x16x32_bf16 v[144:147], v[72:75], v[36:39], 0
    ds_read_b64_tr_b16 v[100:101], v23 offset:12288
    v_mfma_f32_16x16x32_bf16 v[148:151], v[76:79], v[36:39], 0
    ds_read_b64_tr_b16 v[102:103], v23 offset:12800
    ds_read_b128 v[52:55], v15 offset:2048
    s_waitcnt lgkmcnt(15)
    v_mfma_f32_16x16x32_bf16 v[152:155], v[72:75], v[40:43], 0
    ds_read_b128 v[56:59], v15 offset:4096
    v_mfma_f32_16x16x32_bf16 v[156:159], v[76:79], v[40:43], 0
    ds_read_b128 v[60:63], v15 offset:6144
K1_hop493:
    s_cbranch_execz K1_ret
    s_waitcnt lgkmcnt(15)
    v_mfma_f32_16x16x32_bf16 v[160:163], v[72:75], v[44:47], 0
    ds_read_b64_tr_b16 v[88:89], v22 offset:4096
    ds_read_b64_tr_b16 v[90:91], v22 offset:4608
    v_mfma_f32_16x16x32_bf16 v[164:167], v[76:79], v[44:47], 0
    ds_read_b64_tr_b16 v[92:93], v23 offset:4096
    s_waitcnt lgkmcnt(15)
    v_mfma_f32_16x16x32_bf16 v[112:115], v[64:67], v[36:39], 0
    ds_read_b64_tr_b16 v[94:95], v23 offset:4608
    v_mfma_f32_16x16x32_bf16 v[116:119], v[68:71], v[36:39], 0
    ds_read_b64_tr_b16 v[104:105], v22 offset:20480
    ds_read_b64_tr_b16 v[106:107], v22 offset:20992
    v_mfma_f32_16x16x32_bf16 v[120:123], v[64:67], v[40:43], 0
    ds_read_b64_tr_b16 v[108:109], v23 offset:20480
    v_mfma_f32_16x16x32_bf16 v[124:127], v[68:71], v[40:43], 0
    ds_read_b64_tr_b16 v[110:111], v23 offset:20992
K1_hop509:
    s_cbranch_execz K1_ret
    v_mfma_f32_16x16x32_bf16 v[128:131], v[64:67], v[44:47], 0
    v_mfma_f32_16x16x32_bf16 v[132:135], v[68:71], v[44:47], 0
    s_waitcnt lgkmcnt(15)
    v_mfma_f32_16x16x32_bf16 v[168:171], v[32:35], v[80:83], 0
    v_mfma_f32_16x16x32_bf16 v[172:175], v[32:35], v[84:87], 0
    v_mfma_f32_16x16x32_bf16 v[176:179], v[36:39], v[80:83], 0
    v_mfma_f32_16x16x32_bf16 v[180:183], v[36:39], v[84:87], 0
    v_mfma_f32_16x16x32_bf16 v[184:187], v[40:43], v[80:83], 0
    v_mfma_f32_16x16x32_bf16 v[188:191], v[40:43], v[84:87], 0
    v_mfma_f32_16x16x32_bf16 v[192:195], v[44:47], v[80:83], 0
    v_mfma_f32_16x16x32_bf16 v[196:199], v[44:47], v[84:87], 0
    s_barrier
    s_waitcnt lgkmcnt(13)
    v_mfma_f32_16x16x32_bf16 v[136:139], v[96:99], v[48:51], v[136:139]
    ds_read_b128 v[32:35], v16 offset:0
    ds_read_b64_tr_b16 v[72:73], v24 offset:8192
    s_waitcnt lgkmcnt(13)
    v_mfma_f32_16x16x32_bf16 v[140:143], v[100:103], v[48:51], v[140:143]
K1_hop527:
    s_cbranch_execz K1_ret
    ds_read_b64_tr_b16 v[74:75], v24 offset:8704
    s_waitcnt lgkmcnt(13)
    v_mfma_f32_16x16x32_bf16 v[144:147], v[96:99], v[52:55], v[144:147]
    ds_read_b64_tr_b16 v[76:77], v25 offset:8192
    v_mfma_f32_16x16x32_bf16 v[148:151], v[100:103], v[52:55], v[148:151]
    ds_read_b64_tr_b16 v[78:79], v25 offset:8704
    ds_read_b128 v[36:39], v16 offset:2048
    s_waitcnt lgkmcnt(15)
    v_mfma_f32_16x16x32_bf16 v[152:155], v[96:99], v[56:59], v[152:155]
    ds_read_b128 v[40:43], v16 offset:4096
    v_mfma_f32_16x16x32_bf16 v[156:159], v[100:103], v[56:59], v[156:159]
    ds_read_b128 v[44:47], v16 offset:6144
    s_waitcnt lgkmcnt(15)
    v_mfma_f32_16x16x32_bf16 v[160:163], v[96:99], v[60:63], v[160:163]
    ds_read_b64_tr_b16 v[64:65], v24 offset:0
    ds_read_b64_tr_b16 v[66:67], v24 offset:512
    v_mfma_f32_16x16x32_bf16 v[164:167], v[100:103], v[60:63], v[164:167]
K1_hop544:
    s_cbranch_execz K1_ret
    ds_read_b64_tr_b16 v[68:69], v25 offset:0
    s_waitcnt lgkmcnt(15)
    v_mfma_f32_16x16x32_bf16 v[112:115], v[88:91], v[52:55], v[112:115]
    ds_read_b64_tr_b16 v[70:71], v25 offset:512
    v_mfma_f32_16x16x32_bf16 v[116:119], v[92:95], v[52:55], v[116:119]
    ds_read_b64_tr_b16 v[80:81], v24 offset:16384
    ds_read_b64_tr_b16 v[82:83], v24 offset:16896
    v_mfma_f32_16x16x32_bf16 v[120:123], v[88:91], v[56:59], v[120:123]
    ds_read_b64_tr_b16 v[84:85], v25 offset:16384
    v_mfma_f32_16x16x32_bf16 v[124:127], v[92:95], v[56:59], v[124:127]
    ds_read_b64_tr_b16 v[86:87], v25 offset:16896
    v_mfma_f32_16x16x32_bf16 v[128:131], v[88:91], v[60:63], v[128:131]
    v_mfma_f32_16x16x32_bf16 v[132:135], v[92:95], v[60:63], v[132:135]
    s_waitcnt lgkmcnt(15)
    v_mfma_f32_16x16x32_bf16 v[168:171], v[48:51], v[104:107], v[168:171]
    v_mfma_f32_16x16x32_bf16 v[172:175], v[48:51], v[108:111], v[172:175]
K1_hop560:
    s_cbranch_execz K1_ret
    v_mfma_f32_16x16x32_bf16 v[176:179], v[52:55], v[104:107], v[176:179]
    v_mfma_f32_16x16x32_bf16 v[180:183], v[52:55], v[108:111], v[180:183]
    v_mfma_f32_16x16x32_bf16 v[184:187], v[56:59], v[104:107], v[184:187]
    v_mfma_f32_16x16x32_bf16 v[188:191], v[56:59], v[108:111], v[188:191]
    v_mfma_f32_16x16x32_bf16 v[192:195], v[60:63], v[104:107], v[192:195]
    v_mfma_f32_16x16x32_bf16 v[196:199], v[60:63], v[108:111], v[196:199]
    s_waitcnt lgkmcnt(13)
    v_mfma_f32_16x16x32_bf16 v[136:139], v[72:75], v[32:35], v[136:139]
    ds_read_b128 v[48:51], v17 offset:0
    ds_read_b64_tr_b16 v[96:97], v24 offset:12288
    s_waitcnt lgkmcnt(13)
    v_mfma_f32_16x16x32_bf16 v[140:143], v[76:79], v[32:35], v[140:143]
    ds_read_b64_tr_b16 v[98:99], v24 offset:12800
    s_waitcnt lgkmcnt(13)
    v_mfma_f32_16x16x32_bf16 v[144:147], v[72:75], v[36:39], v[144:147]
    ds_read_b64_tr_b16 v[100:101], v25 offset:12288
    v_mfma_f32_16x16x32_bf16 v[148:151], v[76:79], v[36:39], v[148:151]
K1_hop577:
    s_cbranch_execz K1_ret
    ds_read_b64_tr_b16 v[102:103], v25 offset:12800
    ds_read_b128 v[52:55], v17 offset:2048
    s_waitcnt lgkmcnt(15)
    v_mfma_f32_16x16x32_bf16 v[152:155], v[72:75], v[40:43], v[152:155]
    ds_read_b128 v[56:59], v17 offset:4096
    v_mfma_f32_16x16x32_bf16 v[156:159], v[76:79], v[40:43], v[156:159]
    ds_read_b128 v[60:63], v17 offset:6144
    s_waitcnt lgkmcnt(15)
    v_mfma_f32_16x16x32_bf16 v[160:163], v[72:75], v[44:47], v[160:163]
    ds_read_b64_tr_b16 v[88:89], v24 offset:4096
    ds_read_b64_tr_b16 v[90:91], v24 offset:4608
    v_mfma_f32_16x16x32_bf16 v[164:167], v[76:79], v[44:47], v[164:167]
    ds_read_b64_tr_b16 v[92:93], v25 offset:4096
    s_waitcnt lgkmcnt(15)
    v_mfma_f32_16x16x32_bf16 v[112:115], v[64:67], v[36:39], v[112:115]
    ds_read_b64_tr_b16 v[94:95], v25 offset:4608
    v_mfma_f32_16x16x32_bf16 v[116:119], v[68:71], v[36:39], v[116:119]
K1_hop594:
    s_cbranch_execz K1_ret
    ds_read_b64_tr_b16 v[104:105], v24 offset:20480
    ds_read_b64_tr_b16 v[106:107], v24 offset:20992
    v_mfma_f32_16x16x32_bf16 v[120:123], v[64:67], v[40:43], v[120:123]
    ds_read_b64_tr_b16 v[108:109], v25 offset:20480
    v_mfma_f32_16x16x32_bf16 v[124:127], v[68:71], v[40:43], v[124:127]
    ds_read_b64_tr_b16 v[110:111], v25 offset:20992
    v_mfma_f32_16x16x32_bf16 v[128:131], v[64:67], v[44:47], v[128:131]
    v_mfma_f32_16x16x32_bf16 v[132:135], v[68:71], v[44:47], v[132:135]
    s_waitcnt lgkmcnt(15)
    v_mfma_f32_16x16x32_bf16 v[168:171], v[32:35], v[80:83], v[168:171]
    v_mfma_f32_16x16x32_bf16 v[172:175], v[32:35], v[84:87], v[172:175]
    v_mfma_f32_16x16x32_bf16 v[176:179], v[36:39], v[80:83], v[176:179]
    v_mfma_f32_16x16x32_bf16 v[180:183], v[36:39], v[84:87], v[180:183]
    v_mfma_f32_16x16x32_bf16 v[184:187], v[40:43], v[80:83], v[184:187]
    v_mfma_f32_16x16x32_bf16 v[188:191], v[40:43], v[84:87], v[188:191]
    v_mfma_f32_16x16x32_bf16 v[192:195], v[44:47], v[80:83], v[192:195]
K1_hop610:
    s_cbranch_execz K1_ret
    v_mfma_f32_16x16x32_bf16 v[196:199], v[44:47], v[84:87], v[196:199]
    s_barrier
    s_waitcnt lgkmcnt(13)
    v_mfma_f32_16x16x32_bf16 v[136:139], v[96:99], v[48:51], v[136:139]
    ds_read_b128 v[32:35], v18 offset:0
    ds_read_b64_tr_b16 v[72:73], v26 offset:8192
    s_waitcnt lgkmcnt(13)
    v_mfma_f32_16x16x32_bf16 v[140:143], v[100:103], v[48:51], v[140:143]
    ds_read_b64_tr_b16 v[74:75], v26 offset:8704
    s_waitcnt lgkmcnt(13)
    v_mfma_f32_16x16x32_bf16 v[144:147], v[96:99], v[52:55], v[144:147]
    ds_read_b64_tr_b16 v[76:77], v27 offset:8192
    v_mfma_f32_16x16x32_bf16 v[148:151], v[100:103], v[52:55], v[148:151]
    ds_read_b64_tr_b16 v[78:79], v27 offset:8704
    ds_read_b128 v[36:39], v18 offset:2048
    s_waitcnt lgkmcnt(15)
    v_mfma_f32_16x16x32_bf16 v[152:155], v[96:99], v[56:59], v[152:155]
    ds_read_b128 v[40:43], v18 offset:4096
K1_hop628:
    s_cbranch_execz K1_ret
    v_mfma_f32_16x16x32_bf16 v[156:159], v[100:103], v[56:59], v[156:159]
    ds_read_b128 v[44:47], v18 offset:6144
    s_waitcnt lgkmcnt(15)
    v_mfma_f32_16x16x32_bf16 v[160:163], v[96:99], v[60:63], v[160:163]
    ds_read_b64_tr_b16 v[64:65], v26 offset:0
    ds_read_b64_tr_b16 v[66:67], v26 offset:512
    v_mfma_f32_16x16x32_bf16 v[164:167], v[100:103], v[60:63], v[164:167]
    ds_read_b64_tr_b16 v[68:69], v27 offset:0
    s_waitcnt lgkmcnt(15)
    v_mfma_f32_16x16x32_bf16 v[112:115], v[88:91], v[52:55], v[112:115]
    ds_read_b64_tr_b16 v[70:71], v27 offset:512
    v_mfma_f32_16x16x32_bf16 v[116:119], v[92:95], v[52:55], v[116:119]
    ds_read_b64_tr_b16 v[80:81], v26 offset:16384
    ds_read_b64_tr_b16 v[82:83], v26 offset:16896
    v_mfma_f32_16x16x32_bf16 v[120:123], v[88:91], v[56:59], v[120:123]
    ds_read_b64_tr_b16 v[84:85], v27 offset:16384
    v_mfma_f32_16x16x32_bf16 v[124:127], v[92:95], v[56:59], v[124:127]
K1_hop645:
    s_cbranch_execz K1_ret
    ds_read_b64_tr_b16 v[86:87], v27 offset:16896
    v_mfma_f32_16x16x32_bf16 v[128:131], v[88:91], v[60:63], v[128:131]
    v_mfma_f32_16x16x32_bf16 v[132:135], v[92:95], v[60:63], v[132:135]
    s_waitcnt lgkmcnt(15)
    v_mfma_f32_16x16x32_bf16 v[168:171], v[48:51], v[104:107], v[168:171]
    v_mfma_f32_16x16x32_bf16 v[172:175], v[48:51], v[108:111], v[172:175]
    v_mfma_f32_16x16x32_bf16 v[176:179], v[52:55], v[104:107], v[176:179]
    v_mfma_f32_16x16x32_bf16 v[180:183], v[52:55], v[108:111], v[180:183]
    v_mfma_f32_16x16x32_bf16 v[184:187], v[56:59], v[104:107], v[184:187]
    v_mfma_f32_16x16x32_bf16 v[188:191], v[56:59], v[108:111], v[188:191]
    v_mfma_f32_16x16x32_bf16 v[192:195], v[60:63], v[104:107], v[192:195]
    v_mfma_f32_16x16x32_bf16 v[196:199], v[60:63], v[108:111], v[196:199]
    s_waitcnt lgkmcnt(13)
    v_mfma_f32_16x16x32_bf16 v[136:139], v[72:75], v[32:35], v[136:139]
    ds_read_b128 v[48:51], v19 offset:0
    ds_read_b64_tr_b16 v[96:97], v26 offset:12288
K1_hop661:
    s_cbranch_execz K1_ret
    s_waitcnt lgkmcnt(13)
    v_mfma_f32_16x16x32_bf16 v[140:143], v[76:79], v[32:35], v[140:143]
    ds_read_b64_tr_b16 v[98:99], v26 offset:12800
    s_waitcnt lgkmcnt(13)
    v_mfma_f32_16x16x32_bf16 v[144:147], v[72:75], v[36:39], v[144:147]
    ds_read_b64_tr_b16 v[100:101], v27 offset:12288
    v_mfma_f32_16x16x32_bf16 v[148:151], v[76:79], v[36:39], v[148:151]
    ds_read_b64_tr_b16 v[102:103], v27 offset:12800
    ds_read_b128 v[52:55], v19 offset:2048
    s_waitcnt lgkmcnt(15)
    v_mfma_f32_16x16x32_bf16 v[152:155], v[72:75], v[40:43], v[152:155]
    ds_read_b128 v[56:59], v19 offset:4096
    v_mfma_f32_16x16x32_bf16 v[156:159], v[76:79], v[40:43], v[156:159]
    ds_read_b128 v[60:63], v19 offset:6144
    s_waitcnt lgkmcnt(15)
    v_mfma_f32_16x16x32_bf16 v[160:163], v[72:75], v[44:47], v[160:163]
    ds_read_b64_tr_b16 v[88:89], v26 offset:4096
    ds_read_b64_tr_b16 v[90:91], v26 offset:4608
K1_hop679:
    s_cbranch_execz K1_ret
    v_mfma_f32_16x16x32_bf16 v[164:167], v[76:79], v[44:47], v[164:167]
    ds_read_b64_tr_b16 v[92:93], v27 offset:4096
    s_waitcnt lgkmcnt(15)
    v_mfma_f32_16x16x32_bf16 v[112:115], v[64:67], v[36:39], v[112:115]
    ds_read_b64_tr_b16 v[94:95], v27 offset:4608
    v_mfma_f32_16x16x32_bf16 v[116:119], v[68:71], v[36:39], v[116:119]
    ds_read_b64_tr_b16 v[104:105], v26 offset:20480
    ds_read_b64_tr_b16 v[106:107], v26 offset:20992
    v_mfma_f32_16x16x32_bf16 v[120:123], v[64:67], v[40:43], v[120:123]
    ds_read_b64_tr_b16 v[108:109], v27 offset:20480
    v_mfma_f32_16x16x32_bf16 v[124:127], v[68:71], v[40:43], v[124:127]
    ds_read_b64_tr_b16 v[110:111], v27 offset:20992
    v_mfma_f32_16x16x32_bf16 v[128:131], v[64:67], v[44:47], v[128:131]
    v_mfma_f32_16x16x32_bf16 v[132:135], v[68:71], v[44:47], v[132:135]
    s_waitcnt lgkmcnt(15)
    v_mfma_f32_16x16x32_bf16 v[168:171], v[32:35], v[80:83], v[168:171]
K1_hop695:
    s_cbranch_execz K1_ret
    v_mfma_f32_16x16x32_bf16 v[172:175], v[32:35], v[84:87], v[172:175]
    v_mfma_f32_16x16x32_bf16 v[176:179], v[36:39], v[80:83], v[176:179]
    v_mfma_f32_16x16x32_bf16 v[180:183], v[36:39], v[84:87], v[180:183]
    v_mfma_f32_16x16x32_bf16 v[184:187], v[40:43], v[80:83], v[184:187]
    v_mfma_f32_16x16x32_bf16 v[188:191], v[40:43], v[84:87], v[188:191]
    v_mfma_f32_16x16x32_bf16 v[192:195], v[44:47], v[80:83], v[192:195]
    v_mfma_f32_16x16x32_bf16 v[196:199], v[44:47], v[84:87], v[196:199]
    s_barrier
    s_waitcnt lgkmcnt(13)
    v_mfma_f32_16x16x32_bf16 v[136:139], v[96:99], v[48:51], v[136:139]
    ds_read_b128 v[32:35], v20 offset:0
    ds_read_b64_tr_b16 v[72:73], v28 offset:8192
    s_waitcnt lgkmcnt(13)
    v_mfma_f32_16x16x32_bf16 v[140:143], v[100:103], v[48:51], v[140:143]
    ds_read_b64_tr_b16 v[74:75], v28 offset:8704
    s_waitcnt lgkmcnt(13)
    v_mfma_f32_16x16x32_bf16 v[144:147], v[96:99], v[52:55], v[144:147]
    ds_read_b64_tr_b16 v[76:77], v29 offset:8192
K1_hop713:
    s_cbranch_execz K1_ret
    v_mfma_f32_16x16x32_bf16 v[148:151], v[100:103], v[52:55], v[148:151]
    ds_read_b64_tr_b16 v[78:79], v29 offset:8704
    ds_read_b128 v[36:39], v20 offset:2048
    s_waitcnt lgkmcnt(15)
    v_mfma_f32_16x16x32_bf16 v[152:155], v[96:99], v[56:59], v[152:155]
    ds_read_b128 v[40:43], v20 offset:4096
    v_mfma_f32_16x16x32_bf16 v[156:159], v[100:103], v[56:59], v[156:159]
    ds_read_b128 v[44:47], v20 offset:6144
    s_waitcnt lgkmcnt(15)
    v_mfma_f32_16x16x32_bf16 v[160:163], v[96:99], v[60:63], v[160:163]
    ds_read_b64_tr_b16 v[64:65], v28 offset:0
    ds_read_b64_tr_b16 v[66:67], v28 offset:512
    v_mfma_f32_16x16x32_bf16 v[164:167], v[100:103], v[60:63], v[164:167]
    ds_read_b64_tr_b16 v[68:69], v29 offset:0
    s_waitcnt lgkmcnt(15)
    v_mfma_f32_16x16x32_bf16 v[112:115], v[88:91], v[52:55], v[112:115]
    ds_read_b64_tr_b16 v[70:71], v29 offset:512
K1_hop730:
    s_cbranch_execz K1_ret
    v_mfma_f32_16x16x32_bf16 v[116:119], v[92:95], v[52:55], v[116:119]
    ds_read_b64_tr_b16 v[80:81], v28 offset:16384
    ds_read_b64_tr_b16 v[82:83], v28 offset:16896
    v_mfma_f32_16x16x32_bf16 v[120:123], v[88:91], v[56:59], v[120:123]
    ds_read_b64_tr_b16 v[84:85], v29 offset:16384
    v_mfma_f32_16x16x32_bf16 v[124:127], v[92:95], v[56:59], v[124:127]
    ds_read_b64_tr_b16 v[86:87], v29 offset:16896
    v_mfma_f32_16x16x32_bf16 v[128:131], v[88:91], v[60:63], v[128:131]
    v_mfma_f32_16x16x32_bf16 v[132:135], v[92:95], v[60:63], v[132:135]
    s_waitcnt lgkmcnt(15)
    v_mfma_f32_16x16x32_bf16 v[168:171], v[48:51], v[104:107], v[168:171]
    v_mfma_f32_16x16x32_bf16 v[172:175], v[48:51], v[108:111], v[172:175]
    v_mfma_f32_16x16x32_bf16 v[176:179], v[52:55], v[104:107], v[176:179]
    v_mfma_f32_16x16x32_bf16 v[180:183], v[52:55], v[108:111], v[180:183]
    v_mfma_f32_16x16x32_bf16 v[184:187], v[56:59], v[104:107], v[184:187]
    v_mfma_f32_16x16x32_bf16 v[188:191], v[56:59], v[108:111], v[188:191]
K1_hop746:
    s_cbranch_execz K1_ret
    v_mfma_f32_16x16x32_bf16 v[192:195], v[60:63], v[104:107], v[192:195]
    v_mfma_f32_16x16x32_bf16 v[196:199], v[60:63], v[108:111], v[196:199]
    s_waitcnt lgkmcnt(13)
    v_mfma_f32_16x16x32_bf16 v[136:139], v[72:75], v[32:35], v[136:139]
    ds_read_b128 v[48:51], v21 offset:0
    ds_read_b64_tr_b16 v[96:97], v28 offset:12288
    s_waitcnt lgkmcnt(13)
    v_mfma_f32_16x16x32_bf16 v[140:143], v[76:79], v[32:35], v[140:143]
    ds_read_b64_tr_b16 v[98:99], v28 offset:12800
    s_waitcnt lgkmcnt(13)
    v_mfma_f32_16x16x32_bf16 v[144:147], v[72:75], v[36:39], v[144:147]
    ds_read_b64_tr_b16 v[100:101], v29 offset:12288
    v_mfma_f32_16x16x32_bf16 v[148:151], v[76:79], v[36:39], v[148:151]
    ds_read_b64_tr_b16 v[102:103], v29 offset:12800
    ds_read_b128 v[52:55], v21 offset:2048
    s_waitcnt lgkmcnt(15)
    v_mfma_f32_16x16x32_bf16 v[152:155], v[72:75], v[40:43], v[152:155]
K1_hop763:
    s_cbranch_execz K1_ret
    ds_read_b128 v[56:59], v21 offset:4096
    v_mfma_f32_16x16x32_bf16 v[156:159], v[76:79], v[40:43], v[156:159]
    ds_read_b128 v[60:63], v21 offset:6144
    s_waitcnt lgkmcnt(15)
    v_mfma_f32_16x16x32_bf16 v[160:163], v[72:75], v[44:47], v[160:163]
    ds_read_b64_tr_b16 v[88:89], v28 offset:4096
    ds_read_b64_tr_b16 v[90:91], v28 offset:4608
    v_mfma_f32_16x16x32_bf16 v[164:167], v[76:79], v[44:47], v[164:167]
    ds_read_b64_tr_b16 v[92:93], v29 offset:4096
    s_waitcnt lgkmcnt(15)
    v_mfma_f32_16x16x32_bf16 v[112:115], v[64:67], v[36:39], v[112:115]
    ds_read_b64_tr_b16 v[94:95], v29 offset:4608
    v_mfma_f32_16x16x32_bf16 v[116:119], v[68:71], v[36:39], v[116:119]
    ds_read_b64_tr_b16 v[104:105], v28 offset:20480
    ds_read_b64_tr_b16 v[106:107], v28 offset:20992
    v_mfma_f32_16x16x32_bf16 v[120:123], v[64:67], v[40:43], v[120:123]
    ds_read_b64_tr_b16 v[108:109], v29 offset:20480
K1_hop780:
    s_cbranch_execz K1_ret
    v_mfma_f32_16x16x32_bf16 v[124:127], v[68:71], v[40:43], v[124:127]
    ds_read_b64_tr_b16 v[110:111], v29 offset:20992
    v_mfma_f32_16x16x32_bf16 v[128:131], v[64:67], v[44:47], v[128:131]
    v_mfma_f32_16x16x32_bf16 v[132:135], v[68:71], v[44:47], v[132:135]
    s_waitcnt lgkmcnt(15)
    v_mfma_f32_16x16x32_bf16 v[168:171], v[32:35], v[80:83], v[168:171]
    v_mfma_f32_16x16x32_bf16 v[172:175], v[32:35], v[84:87], v[172:175]
    v_mfma_f32_16x16x32_bf16 v[176:179], v[36:39], v[80:83], v[176:179]
    v_mfma_f32_16x16x32_bf16 v[180:183], v[36:39], v[84:87], v[180:183]
    v_mfma_f32_16x16x32_bf16 v[184:187], v[40:43], v[80:83], v[184:187]
    v_mfma_f32_16x16x32_bf16 v[188:191], v[40:43], v[84:87], v[188:191]
    v_mfma_f32_16x16x32_bf16 v[192:195], v[44:47], v[80:83], v[192:195]
    v_mfma_f32_16x16x32_bf16 v[196:199], v[44:47], v[84:87], v[196:199]
    s_barrier
    s_waitcnt lgkmcnt(13)
    v_mfma_f32_16x16x32_bf16 v[136:139], v[96:99], v[48:51], v[136:139]
    ds_read_b128 v[32:35], v14 offset:0
K1_hop797:
    s_cbranch_execz K1_ret
    ds_read_b64_tr_b16 v[72:73], v22 offset:8192
    s_waitcnt lgkmcnt(13)
    v_mfma_f32_16x16x32_bf16 v[140:143], v[100:103], v[48:51], v[140:143]
    ds_read_b64_tr_b16 v[74:75], v22 offset:8704
    s_waitcnt lgkmcnt(13)
    v_mfma_f32_16x16x32_bf16 v[144:147], v[96:99], v[52:55], v[144:147]
    ds_read_b64_tr_b16 v[76:77], v23 offset:8192
    v_mfma_f32_16x16x32_bf16 v[148:151], v[100:103], v[52:55], v[148:151]
    ds_read_b64_tr_b16 v[78:79], v23 offset:8704
    ds_read_b128 v[36:39], v14 offset:2048
    s_waitcnt lgkmcnt(15)
    v_mfma_f32_16x16x32_bf16 v[152:155], v[96:99], v[56:59], v[152:155]
    ds_read_b128 v[40:43], v14 offset:4096
    v_mfma_f32_16x16x32_bf16 v[156:159], v[100:103], v[56:59], v[156:159]
    ds_read_b128 v[44:47], v14 offset:6144
    s_waitcnt lgkmcnt(15)
    v_mfma_f32_16x16x32_bf16 v[160:163], v[96:99], v[60:63], v[160:163]
K1_hop814:
    s_cbranch_execz K1_ret
    ds_read_b64_tr_b16 v[64:65], v22 offset:0
    ds_read_b64_tr_b16 v[66:67], v22 offset:512
    v_mfma_f32_16x16x32_bf16 v[164:167], v[100:103], v[60:63], v[164:167]
    ds_read_b64_tr_b16 v[68:69], v23 offset:0
    s_waitcnt lgkmcnt(15)
    v_mfma_f32_16x16x32_bf16 v[112:115], v[88:91], v[52:55], v[112:115]
    ds_read_b64_tr_b16 v[70:71], v23 offset:512
    v_mfma_f32_16x16x32_bf16 v[116:119], v[92:95], v[52:55], v[116:119]
    ds_read_b64_tr_b16 v[80:81], v22 offset:16384
    ds_read_b64_tr_b16 v[82:83], v22 offset:16896
    v_mfma_f32_16x16x32_bf16 v[120:123], v[88:91], v[56:59], v[120:123]
    ds_read_b64_tr_b16 v[84:85], v23 offset:16384
    v_mfma_f32_16x16x32_bf16 v[124:127], v[92:95], v[56:59], v[124:127]
    ds_read_b64_tr_b16 v[86:87], v23 offset:16896
    v_mfma_f32_16x16x32_bf16 v[128:131], v[88:91], v[60:63], v[128:131]
    v_mfma_f32_16x16x32_bf16 v[132:135], v[92:95], v[60:63], v[132:135]
K1_hop830:
    s_cbranch_execz K1_ret
    s_waitcnt lgkmcnt(15)
    v_mfma_f32_16x16x32_bf16 v[168:171], v[48:51], v[104:107], v[168:171]
    v_mfma_f32_16x16x32_bf16 v[172:175], v[48:51], v[108:111], v[172:175]
    v_mfma_f32_16x16x32_bf16 v[176:179], v[52:55], v[104:107], v[176:179]
    v_mfma_f32_16x16x32_bf16 v[180:183], v[52:55], v[108:111], v[180:183]
    v_mfma_f32_16x16x32_bf16 v[184:187], v[56:59], v[104:107], v[184:187]
    v_mfma_f32_16x16x32_bf16 v[188:191], v[56:59], v[108:111], v[188:191]
    v_mfma_f32_16x16x32_bf16 v[192:195], v[60:63], v[104:107], v[192:195]
    v_mfma_f32_16x16x32_bf16 v[196:199], v[60:63], v[108:111], v[196:199]
    s_waitcnt lgkmcnt(13)
    v_mfma_f32_16x16x32_bf16 v[136:139], v[72:75], v[32:35], v[136:139]
    ds_read_b128 v[48:51], v15 offset:0
    ds_read_b64_tr_b16 v[96:97], v22 offset:12288
    s_waitcnt lgkmcnt(13)
    v_mfma_f32_16x16x32_bf16 v[140:143], v[76:79], v[32:35], v[140:143]
    ds_read_b64_tr_b16 v[98:99], v22 offset:12800
    s_waitcnt lgkmcnt(13)
    v_mfma_f32_16x16x32_bf16 v[144:147], v[72:75], v[36:39], v[144:147]
K1_hop848:
    s_cbranch_execz K1_ret
    ds_read_b64_tr_b16 v[100:101], v23 offset:12288
    v_mfma_f32_16x16x32_bf16 v[148:151], v[76:79], v[36:39], v[148:151]
    ds_read_b64_tr_b16 v[102:103], v23 offset:12800
    ds_read_b128 v[52:55], v15 offset:2048
    s_waitcnt lgkmcnt(15)
    v_mfma_f32_16x16x32_bf16 v[152:155], v[72:75], v[40:43], v[152:155]
    ds_read_b128 v[56:59], v15 offset:4096
    v_mfma_f32_16x16x32_bf16 v[156:159], v[76:79], v[40:43], v[156:159]
    ds_read_b128 v[60:63], v15 offset:6144
    s_waitcnt lgkmcnt(15)
    v_mfma_f32_16x16x32_bf16 v[160:163], v[72:75], v[44:47], v[160:163]
    ds_read_b64_tr_b16 v[88:89], v22 offset:4096
    ds_read_b64_tr_b16 v[90:91], v22 offset:4608
    v_mfma_f32_16x16x32_bf16 v[164:167], v[76:79], v[44:47], v[164:167]
    ds_read_b64_tr_b16 v[92:93], v23 offset:4096
    s_waitcnt lgkmcnt(15)
    v_mfma_f32_16x16x32_bf16 v[112:115], v[64:67], v[36:39], v[112:115]
K1_hop865:
    s_cbranch_execz K1_ret
    ds_read_b64_tr_b16 v[94:95], v23 offset:4608
    v_mfma_f32_16x16x32_bf16 v[116:119], v[68:71], v[36:39], v[116:119]
    ds_read_b64_tr_b16 v[104:105], v22 offset:20480
    ds_read_b64_tr_b16 v[106:107], v22 offset:20992
    v_mfma_f32_16x16x32_bf16 v[120:123], v[64:67], v[40:43], v[120:123]
    ds_read_b64_tr_b16 v[108:109], v23 offset:20480
    v_mfma_f32_16x16x32_bf16 v[124:127], v[68:71], v[40:43], v[124:127]
    ds_read_b64_tr_b16 v[110:111], v23 offset:20992
    v_mfma_f32_16x16x32_bf16 v[128:131], v[64:67], v[44:47], v[128:131]
    v_mfma_f32_16x16x32_bf16 v[132:135], v[68:71], v[44:47], v[132:135]
    s_waitcnt lgkmcnt(15)
    v_mfma_f32_16x16x32_bf16 v[168:171], v[32:35], v[80:83], v[168:171]
    v_mfma_f32_16x16x32_bf16 v[172:175], v[32:35], v[84:87], v[172:175]
    v_mfma_f32_16x16x32_bf16 v[176:179], v[36:39], v[80:83], v[176:179]
    v_mfma_f32_16x16x32_bf16 v[180:183], v[36:39], v[84:87], v[180:183]
    v_mfma_f32_16x16x32_bf16 v[184:187], v[40:43], v[80:83], v[184:187]
K1_hop881:
    s_cbranch_execz K1_ret
    v_mfma_f32_16x16x32_bf16 v[188:191], v[40:43], v[84:87], v[188:191]
    v_mfma_f32_16x16x32_bf16 v[192:195], v[44:47], v[80:83], v[192:195]
    v_mfma_f32_16x16x32_bf16 v[196:199], v[44:47], v[84:87], v[196:199]
    s_barrier
    s_waitcnt lgkmcnt(13)
    v_mfma_f32_16x16x32_bf16 v[136:139], v[96:99], v[48:51], v[136:139]
    ds_read_b128 v[32:35], v16 offset:0
    ds_read_b64_tr_b16 v[72:73], v24 offset:8192
    s_waitcnt lgkmcnt(13)
    v_mfma_f32_16x16x32_bf16 v[140:143], v[100:103], v[48:51], v[140:143]
    ds_read_b64_tr_b16 v[74:75], v24 offset:8704
    s_waitcnt lgkmcnt(13)
    v_mfma_f32_16x16x32_bf16 v[144:147], v[96:99], v[52:55], v[144:147]
    ds_read_b64_tr_b16 v[76:77], v25 offset:8192
    v_mfma_f32_16x16x32_bf16 v[148:151], v[100:103], v[52:55], v[148:151]
    ds_read_b64_tr_b16 v[78:79], v25 offset:8704
    ds_read_b128 v[36:39], v16 offset:2048
K1_hop898:
    s_cbranch_execz K1_ret
    s_waitcnt lgkmcnt(15)
    v_mfma_f32_16x16x32_bf16 v[152:155], v[96:99], v[56:59], v[152:155]
    ds_read_b128 v[40:43], v16 offset:4096
    v_mfma_f32_16x16x32_bf16 v[156:159], v[100:103], v[56:59], v[156:159]
    ds_read_b128 v[44:47], v16 offset:6144
    s_waitcnt lgkmcnt(15)
    v_mfma_f32_16x16x32_bf16 v[160:163], v[96:99], v[60:63], v[160:163]
    ds_read_b64_tr_b16 v[64:65], v24 offset:0
    ds_read_b64_tr_b16 v[66:67], v24 offset:512
    v_mfma_f32_16x16x32_bf16 v[164:167], v[100:103], v[60:63], v[164:167]
    ds_read_b64_tr_b16 v[68:69], v25 offset:0
    s_waitcnt lgkmcnt(15)
    v_mfma_f32_16x16x32_bf16 v[112:115], v[88:91], v[52:55], v[112:115]
    ds_read_b64_tr_b16 v[70:71], v25 offset:512
    v_mfma_f32_16x16x32_bf16 v[116:119], v[92:95], v[52:55], v[116:119]
    v_mfma_f32_16x16x32_bf16 v[120:123], v[88:91], v[56:59], v[120:123]
    v_mfma_f32_16x16x32_bf16 v[124:127], v[92:95], v[56:59], v[124:127]
K1_hop915:
    s_cbranch_execz K1_ret
    v_mfma_f32_16x16x32_bf16 v[128:131], v[88:91], v[60:63], v[128:131]
    v_mfma_f32_16x16x32_bf16 v[132:135], v[92:95], v[60:63], v[132:135]
    s_waitcnt lgkmcnt(14)
    v_mfma_f32_16x16x32_bf16 v[168:171], v[48:51], v[104:107], v[168:171]
    s_waitcnt lgkmcnt(12)
    v_mfma_f32_16x16x32_bf16 v[172:175], v[48:51], v[108:111], v[172:175]
    v_mfma_f32_16x16x32_bf16 v[176:179], v[52:55], v[104:107], v[176:179]
    v_mfma_f32_16x16x32_bf16 v[180:183], v[52:55], v[108:111], v[180:183]
    v_mfma_f32_16x16x32_bf16 v[184:187], v[56:59], v[104:107], v[184:187]
    v_mfma_f32_16x16x32_bf16 v[188:191], v[56:59], v[108:111], v[188:191]
    v_mfma_f32_16x16x32_bf16 v[192:195], v[60:63], v[104:107], v[192:195]
    v_mfma_f32_16x16x32_bf16 v[196:199], v[60:63], v[108:111], v[196:199]
    s_waitcnt lgkmcnt(9)
    v_mfma_f32_16x16x32_bf16 v[136:139], v[72:75], v[32:35], v[136:139]
    ds_read_b128 v[48:51], v17 offset:0
    ds_read_b64_tr_b16 v[96:97], v24 offset:12288
    s_waitcnt lgkmcnt(9)
    v_mfma_f32_16x16x32_bf16 v[140:143], v[76:79], v[32:35], v[140:143]
K1_hop933:
    s_cbranch_execz K1_ret
    ds_read_b64_tr_b16 v[98:99], v24 offset:12800
    s_waitcnt lgkmcnt(9)
    v_mfma_f32_16x16x32_bf16 v[144:147], v[72:75], v[36:39], v[144:147]
    ds_read_b64_tr_b16 v[100:101], v25 offset:12288
    v_mfma_f32_16x16x32_bf16 v[148:151], v[76:79], v[36:39], v[148:151]
    ds_read_b64_tr_b16 v[102:103], v25 offset:12800
    ds_read_b128 v[52:55], v17 offset:2048
    s_waitcnt lgkmcnt(11)
    v_mfma_f32_16x16x32_bf16 v[152:155], v[72:75], v[40:43], v[152:155]
    ds_read_b128 v[56:59], v17 offset:4096
    v_mfma_f32_16x16x32_bf16 v[156:159], v[76:79], v[40:43], v[156:159]
    ds_read_b128 v[60:63], v17 offset:6144
    s_waitcnt lgkmcnt(12)
    v_mfma_f32_16x16x32_bf16 v[160:163], v[72:75], v[44:47], v[160:163]
    ds_read_b64_tr_b16 v[88:89], v24 offset:4096
    ds_read_b64_tr_b16 v[90:91], v24 offset:4608
    v_mfma_f32_16x16x32_bf16 v[164:167], v[76:79], v[44:47], v[164:167]
K1_hop950:
    s_cbranch_execz K1_ret
    ds_read_b64_tr_b16 v[92:93], v25 offset:4096
    s_waitcnt lgkmcnt(13)
    v_mfma_f32_16x16x32_bf16 v[112:115], v[64:67], v[36:39], v[112:115]
    ds_read_b64_tr_b16 v[94:95], v25 offset:4608
    s_waitcnt lgkmcnt(12)
    v_mfma_f32_16x16x32_bf16 v[116:119], v[68:71], v[36:39], v[116:119]
    v_mfma_f32_16x16x32_bf16 v[120:123], v[64:67], v[40:43], v[120:123]
    v_mfma_f32_16x16x32_bf16 v[124:127], v[68:71], v[40:43], v[124:127]
    v_mfma_f32_16x16x32_bf16 v[128:131], v[64:67], v[44:47], v[128:131]
    v_mfma_f32_16x16x32_bf16 v[132:135], v[68:71], v[44:47], v[132:135]
    s_waitcnt lgkmcnt(9)
    v_mfma_f32_16x16x32_bf16 v[136:139], v[96:99], v[48:51], v[136:139]
    s_waitcnt lgkmcnt(7)
    v_mfma_f32_16x16x32_bf16 v[140:143], v[100:103], v[48:51], v[140:143]
    s_waitcnt lgkmcnt(6)
    v_mfma_f32_16x16x32_bf16 v[144:147], v[96:99], v[52:55], v[144:147]
    v_mfma_f32_16x16x32_bf16 v[148:151], v[100:103], v[52:55], v[148:151]
    s_waitcnt lgkmcnt(5)
K1_hop968:
    s_cbranch_execz K1_ret
    v_mfma_f32_16x16x32_bf16 v[152:155], v[96:99], v[56:59], v[152:155]
    v_mfma_f32_16x16x32_bf16 v[156:159], v[100:103], v[56:59], v[156:159]
    s_waitcnt lgkmcnt(4)
    v_mfma_f32_16x16x32_bf16 v[160:163], v[96:99], v[60:63], v[160:163]
    v_mfma_f32_16x16x32_bf16 v[164:167], v[100:103], v[60:63], v[164:167]
    s_barrier
    s_waitcnt lgkmcnt(2)
    v_mfma_f32_16x16x32_bf16 v[112:115], v[88:91], v[52:55], v[112:115]
    ds_read_b128 v[32:35], v18 offset:0
    ds_read_b64_tr_b16 v[72:73], v26 offset:8192
    s_waitcnt lgkmcnt(2)
    v_mfma_f32_16x16x32_bf16 v[116:119], v[92:95], v[52:55], v[116:119]
    ds_read_b64_tr_b16 v[74:75], v26 offset:8704
    ds_read_b64_tr_b16 v[76:77], v27 offset:8192
    v_mfma_f32_16x16x32_bf16 v[120:123], v[88:91], v[56:59], v[120:123]
    ds_read_b64_tr_b16 v[78:79], v27 offset:8704
    ds_read_b128 v[36:39], v18 offset:2048
    v_mfma_f32_16x16x32_bf16 v[124:127], v[92:95], v[56:59], v[124:127]
K1_hop986:
    s_cbranch_execz K1_ret
    ds_read_b128 v[40:43], v18 offset:4096
    ds_read_b128 v[44:47], v18 offset:6144
    v_mfma_f32_16x16x32_bf16 v[128:131], v[88:91], v[60:63], v[128:131]
    ds_read_b64_tr_b16 v[64:65], v26 offset:0
    ds_read_b64_tr_b16 v[66:67], v26 offset:512
    v_mfma_f32_16x16x32_bf16 v[132:135], v[92:95], v[60:63], v[132:135]
    ds_read_b64_tr_b16 v[68:69], v27 offset:0
    ds_read_b64_tr_b16 v[70:71], v27 offset:512
    s_waitcnt lgkmcnt(9)
    v_mfma_f32_16x16x32_bf16 v[136:139], v[72:75], v[32:35], v[136:139]
    s_waitcnt lgkmcnt(7)
    v_mfma_f32_16x16x32_bf16 v[140:143], v[76:79], v[32:35], v[140:143]
    s_waitcnt lgkmcnt(6)
    v_mfma_f32_16x16x32_bf16 v[144:147], v[72:75], v[36:39], v[144:147]
    v_mfma_f32_16x16x32_bf16 v[148:151], v[76:79], v[36:39], v[148:151]
    s_waitcnt lgkmcnt(5)
    v_mfma_f32_16x16x32_bf16 v[152:155], v[72:75], v[40:43], v[152:155]
K1_hop1003:
    s_cbranch_execz K1_ret
    v_mfma_f32_16x16x32_bf16 v[156:159], v[76:79], v[40:43], v[156:159]
    s_barrier
    s_waitcnt lgkmcnt(4)
    v_mfma_f32_16x16x32_bf16 v[160:163], v[72:75], v[44:47], v[160:163]
    ds_read_b128 v[48:51], v19 offset:0
    ds_read_b64_tr_b16 v[96:97], v26 offset:12288
    v_mfma_f32_16x16x32_bf16 v[164:167], v[76:79], v[44:47], v[164:167]
    ds_read_b64_tr_b16 v[98:99], v26 offset:12800
    s_waitcnt lgkmcnt(5)
    v_mfma_f32_16x16x32_bf16 v[112:115], v[64:67], v[36:39], v[112:115]
    ds_read_b64_tr_b16 v[100:101], v27 offset:12288
    ds_read_b64_tr_b16 v[102:103], v27 offset:12800
    s_waitcnt lgkmcnt(5)
    v_mfma_f32_16x16x32_bf16 v[116:119], v[68:71], v[36:39], v[116:119]
    ds_read_b128 v[52:55], v19 offset:2048
    v_mfma_f32_16x16x32_bf16 v[120:123], v[64:67], v[40:43], v[120:123]
    ds_read_b128 v[56:59], v19 offset:4096
    ds_read_b128 v[60:63], v19 offset:6144
K1_hop1021:
    s_cbranch_execz K1_ret
    v_mfma_f32_16x16x32_bf16 v[124:127], v[68:71], v[40:43], v[124:127]
    ds_read_b64_tr_b16 v[88:89], v26 offset:4096
    v_mfma_f32_16x16x32_bf16 v[128:131], v[64:67], v[44:47], v[128:131]
    ds_read_b64_tr_b16 v[90:91], v26 offset:4608
    ds_read_b64_tr_b16 v[92:93], v27 offset:4096
    v_mfma_f32_16x16x32_bf16 v[132:135], v[68:71], v[44:47], v[132:135]
    ds_read_b64_tr_b16 v[94:95], v27 offset:4608
    s_waitcnt lgkmcnt(9)
    v_mfma_f32_16x16x32_bf16 v[136:139], v[96:99], v[48:51], v[136:139]
    s_waitcnt lgkmcnt(7)
    v_mfma_f32_16x16x32_bf16 v[140:143], v[100:103], v[48:51], v[140:143]
    s_waitcnt lgkmcnt(6)
    v_mfma_f32_16x16x32_bf16 v[144:147], v[96:99], v[52:55], v[144:147]
    v_mfma_f32_16x16x32_bf16 v[148:151], v[100:103], v[52:55], v[148:151]
    s_waitcnt lgkmcnt(5)
    v_mfma_f32_16x16x32_bf16 v[152:155], v[96:99], v[56:59], v[152:155]
    v_mfma_f32_16x16x32_bf16 v[156:159], v[100:103], v[56:59], v[156:159]
K1_hop1038:
    s_cbranch_execz K1_ret
    s_waitcnt lgkmcnt(4)
    v_mfma_f32_16x16x32_bf16 v[160:163], v[96:99], v[60:63], v[160:163]
    v_mfma_f32_16x16x32_bf16 v[164:167], v[100:103], v[60:63], v[164:167]
    s_waitcnt lgkmcnt(2)
    v_mfma_f32_16x16x32_bf16 v[112:115], v[88:91], v[52:55], v[112:115]
    s_waitcnt lgkmcnt(0)
    v_mfma_f32_16x16x32_bf16 v[116:119], v[92:95], v[52:55], v[116:119]
    v_mfma_f32_16x16x32_bf16 v[120:123], v[88:91], v[56:59], v[120:123]
    v_cvt_pk_bf16_f32 v32, v136, v137
    v_cvt_pk_bf16_f32 v33, v138, v139
    v_mfma_f32_16x16x32_bf16 v[124:127], v[92:95], v[56:59], v[124:127]
    v_cvt_pk_bf16_f32 v34, v140, v141
    v_cvt_pk_bf16_f32 v35, v142, v143
    v_mfma_f32_16x16x32_bf16 v[128:131], v[88:91], v[60:63], v[128:131]
    v_cvt_pk_bf16_f32 v36, v144, v145
    v_cvt_pk_bf16_f32 v37, v146, v147
    v_mfma_f32_16x16x32_bf16 v[132:135], v[92:95], v[60:63], v[132:135]
K1_hop1055:
    s_cbranch_execz K1_ret
    v_cvt_pk_bf16_f32 v38, v148, v149
    v_cvt_pk_bf16_f32 v39, v150, v151
    v_cvt_pk_bf16_f32 v40, v152, v153
    v_cvt_pk_bf16_f32 v41, v154, v155
    v_cvt_pk_bf16_f32 v42, v156, v157
    v_cvt_pk_bf16_f32 v43, v158, v159
    v_cvt_pk_bf16_f32 v44, v160, v161
    v_cvt_pk_bf16_f32 v45, v162, v163
    v_cvt_pk_bf16_f32 v46, v164, v165
    v_cvt_pk_bf16_f32 v47, v166, v167
    v_cvt_pk_bf16_f32 v64, v112, v113
    v_cvt_pk_bf16_f32 v65, v114, v115
    s_barrier
    ds_read_b128 v[216:219], v16 offset:0
    v_cvt_pk_bf16_f32 v66, v116, v117
    v_cvt_pk_bf16_f32 v67, v118, v119
K1_hop1071:
    s_cbranch_execz K1_ret
    ds_read_b64_tr_b16 v[80:81], v24 offset:16384
    v_cndmask_b32 v66, 0, v66, s[38:39]
    v_cndmask_b32 v67, 0, v67, s[38:39]
    ds_read_b64_tr_b16 v[82:83], v24 offset:16896
    v_cvt_pk_bf16_f32 v68, v120, v121
    v_cvt_pk_bf16_f32 v69, v122, v123
    ds_read_b64_tr_b16 v[84:85], v25 offset:16384
    v_cvt_pk_bf16_f32 v70, v124, v125
    v_cvt_pk_bf16_f32 v71, v126, v127
    ds_read_b64_tr_b16 v[86:87], v25 offset:16896
    v_cndmask_b32 v70, 0, v70, s[38:39]
    v_cndmask_b32 v71, 0, v71, s[38:39]
    ds_read_b128 v[220:223], v16 offset:2048
    v_cvt_pk_bf16_f32 v72, v128, v129
    v_cvt_pk_bf16_f32 v73, v130, v131
    ds_read_b128 v[224:227], v16 offset:4096
K1_hop1087:
    s_cbranch_execz K1_ret
    v_cvt_pk_bf16_f32 v74, v132, v133
    v_cvt_pk_bf16_f32 v75, v134, v135
    ds_read_b128 v[228:231], v16 offset:6144
    v_cndmask_b32 v74, 0, v74, s[38:39]
    v_cndmask_b32 v75, 0, v75, s[38:39]
    s_waitcnt lgkmcnt(5)
    v_mfma_f32_16x16x32_bf16 v[168:171], v[216:219], v[80:83], v[168:171]
    v_mfma_f32_16x16x32_bf16 v[136:139], v[32:35], v[64:67], v[208:211]
    v_mfma_f32_16x16x32_bf16 v[140:143], v[36:39], v[64:67], v[204:207]
    ds_read_b128 v[48:51], v17 offset:0
    v_mfma_f32_16x16x32_bf16 v[144:147], v[36:39], v[68:71], v[200:203]
    v_mfma_f32_16x16x32_bf16 v[148:151], v[40:43], v[68:71], v[204:207]
    s_waitcnt lgkmcnt(4)
    v_mfma_f32_16x16x32_bf16 v[172:175], v[216:219], v[84:87], v[172:175]
    v_mfma_f32_16x16x32_bf16 v[152:155], v[40:43], v[72:75], v[200:203]
    v_mfma_f32_16x16x32_bf16 v[156:159], v[44:47], v[72:75], v[204:207]
K1_hop1103:
    s_cbranch_execz K1_ret
    ds_read_b64_tr_b16 v[104:105], v24 offset:20480
    s_mov_b32 s32, 0x3e8b97f6
    v_max3_f32 v112, v136, v137, v138
    s_waitcnt lgkmcnt(4)
    v_mfma_f32_16x16x32_bf16 v[176:179], v[220:223], v[80:83], v[176:179]
    v_max3_f32 v116, v144, v145, v146
    s_nop 0
    v_max3_f32 v120, v152, v153, v154
    ds_read_b64_tr_b16 v[106:107], v24 offset:20992
    v_max3_f32 v113, v139, v140, v141
    v_max3_f32 v117, v147, v148, v149
    v_mfma_f32_16x16x32_bf16 v[180:183], v[220:223], v[84:87], v[180:183]
    v_max3_f32 v121, v155, v156, v157
    v_max3_f32 v112, v112, v142, v143
    ds_read_b64_tr_b16 v[108:109], v25 offset:20480
    v_max3_f32 v116, v116, v150, v151
    s_waitcnt lgkmcnt(5)
K1_hop1120:
    s_cbranch_execz K1_ret
    v_mfma_f32_16x16x32_bf16 v[184:187], v[224:227], v[80:83], v[184:187]
    v_max3_f32 v120, v120, v158, v159
    v_max_f32 v112, v112, v113
    ds_read_b64_tr_b16 v[110:111], v25 offset:20992
    v_max_f32 v116, v116, v117
    v_max_f32 v120, v120, v121
    v_mfma_f32_16x16x32_bf16 v[188:191], v[224:227], v[84:87], v[188:191]
    v_mov_b32 v113, v112
    v_mov_b32 v117, v116
    ds_read_b128 v[52:55], v17 offset:2048
    v_mov_b32 v121, v120
    v_permlane16_swap_b32 v112, v113
    s_waitcnt lgkmcnt(6)
    v_mfma_f32_16x16x32_bf16 v[192:195], v[228:231], v[80:83], v[192:195]
    v_permlane16_swap_b32 v116, v117
    v_permlane16_swap_b32 v120, v121
    ds_read_b128 v[56:59], v17 offset:4096
    v_max_f32 v112, v112, v113
    v_max_f32 v116, v116, v117
    v_mfma_f32_16x16x32_bf16 v[196:199], v[228:231], v[84:87], v[196:199]
    v_max_f32 v120, v120, v121
    ds_read_b128 v[60:63], v17 offset:6144
K1_hop1142:
    s_cbranch_execz K1_ret
    v_mov_b32 v113, v112
    v_mov_b32 v117, v116
    s_barrier
    v_mov_b32 v121, v120
    v_permlane32_swap_b32 v112, v113
    s_waitcnt lgkmcnt(5)
    v_mfma_f32_16x16x32_bf16 v[168:171], v[48:51], v[104:107], v[168:171]
    v_permlane32_swap_b32 v116, v117
    v_permlane32_swap_b32 v120, v121
    ds_read_b128 v[216:219], v18 offset:0
    v_max_f32 v112, v112, v113
    v_max_f32 v116, v116, v117
    s_waitcnt lgkmcnt(4)
    v_mfma_f32_16x16x32_bf16 v[172:175], v[48:51], v[108:111], v[172:175]
    v_max_f32 v120, v120, v121
    v_mul_f32 v112, s32, v112
    ds_read_b64_tr_b16 v[80:81], v26 offset:16384
    v_mul_f32 v116, s32, v116
    v_mul_f32 v120, s32, v120
    s_waitcnt lgkmcnt(4)
    v_mfma_f32_16x16x32_bf16 v[176:179], v[52:55], v[104:107], v[176:179]
    v_fma_f32 v136, v136, s32, -v112
    ds_read_b64_tr_b16 v[82:83], v26 offset:16896
    v_fma_f32 v137, v137, s32, -v112
K1_hop1166:
    s_cbranch_execz K1_ret
    v_fma_f32 v138, v138, s32, -v112
    v_mfma_f32_16x16x32_bf16 v[180:183], v[52:55], v[108:111], v[180:183]
    v_fma_f32 v139, v139, s32, -v112
    v_fma_f32 v140, v140, s32, -v112
    ds_read_b64_tr_b16 v[84:85], v27 offset:16384
    v_fma_f32 v141, v141, s32, -v112
    v_fma_f32 v142, v142, s32, -v112
    s_waitcnt lgkmcnt(5)
    v_mfma_f32_16x16x32_bf16 v[184:187], v[56:59], v[104:107], v[184:187]
    v_fma_f32 v143, v143, s32, -v112
    v_fma_f32 v144, v144, s32, -v116
    ds_read_b64_tr_b16 v[86:87], v27 offset:16896
    v_fma_f32 v145, v145, s32, -v116
    v_fma_f32 v146, v146, s32, -v116
    v_mfma_f32_16x16x32_bf16 v[188:191], v[56:59], v[108:111], v[188:191]
    v_fma_f32 v147, v147, s32, -v116
K1_hop1182:
    s_cbranch_execz K1_ret
    v_fma_f32 v148, v148, s32, -v116
    ds_read_b128 v[220:223], v18 offset:2048
    v_fma_f32 v149, v149, s32, -v116
    s_waitcnt lgkmcnt(6)
    v_mfma_f32_16x16x32_bf16 v[192:195], v[60:63], v[104:107], v[192:195]
    v_fma_f32 v150, v150, s32, -v116
    v_fma_f32 v151, v151, s32, -v116
    ds_read_b128 v[224:227], v18 offset:4096
    v_fma_f32 v152, v152, s32, -v120
    v_fma_f32 v153, v153, s32, -v120
    v_mfma_f32_16x16x32_bf16 v[196:199], v[60:63], v[108:111], v[196:199]
    v_fma_f32 v154, v154, s32, -v120
    v_fma_f32 v155, v155, s32, -v120
    ds_read_b128 v[228:231], v18 offset:6144
    v_fma_f32 v156, v156, s32, -v120
    v_fma_f32 v157, v157, s32, -v120
K1_hop1198:
    s_cbranch_execz K1_ret
    s_waitcnt lgkmcnt(5)
    v_mfma_f32_16x16x32_bf16 v[168:171], v[216:219], v[80:83], v[168:171]
    v_fma_f32 v158, v158, s32, -v120
    v_fma_f32 v159, v159, s32, -v120
    ds_read_b128 v[48:51], v19 offset:0
    v_exp_f32 v136, v136
    v_exp_f32 v137, v137
    s_waitcnt lgkmcnt(4)
    v_mfma_f32_16x16x32_bf16 v[172:175], v[216:219], v[84:87], v[172:175]
    v_exp_f32 v138, v138
    ds_read_b64_tr_b16 v[104:105], v26 offset:20480
    v_exp_f32 v139, v139
    v_exp_f32 v140, v140
    s_waitcnt lgkmcnt(4)
    v_mfma_f32_16x16x32_bf16 v[176:179], v[220:223], v[80:83], v[176:179]
    v_exp_f32 v141, v141
    v_exp_f32 v142, v142
    ds_read_b64_tr_b16 v[106:107], v26 offset:20992
    v_exp_f32 v143, v143
    v_cvt_pk_bf16_f32 v64, v136, v137
    v_mfma_f32_16x16x32_bf16 v[180:183], v[220:223], v[84:87], v[180:183]
K1_hop1219:
    s_cbranch_execz K1_ret
    v_cvt_pk_bf16_f32 v65, v138, v139
    v_cvt_pk_bf16_f32 v66, v140, v141
    ds_read_b64_tr_b16 v[108:109], v27 offset:20480
    v_cvt_pk_bf16_f32 v67, v142, v143
    v_exp_f32 v144, v144
    s_waitcnt lgkmcnt(5)
    v_mfma_f32_16x16x32_bf16 v[184:187], v[224:227], v[80:83], v[184:187]
    v_exp_f32 v145, v145
    v_exp_f32 v146, v146
    ds_read_b64_tr_b16 v[110:111], v27 offset:20992
    v_exp_f32 v147, v147
    v_mfma_f32_16x16x32_bf16 v[188:191], v[224:227], v[84:87], v[188:191]
    v_exp_f32 v148, v148
    v_exp_f32 v149, v149
    ds_read_b128 v[52:55], v19 offset:2048
    v_exp_f32 v150, v150
    v_exp_f32 v151, v151
    s_waitcnt lgkmcnt(6)
    v_mfma_f32_16x16x32_bf16 v[192:195], v[228:231], v[80:83], v[192:195]
    v_cvt_pk_bf16_f32 v68, v144, v145
K1_hop1239:
    s_cbranch_execz K1_ret
    v_cvt_pk_bf16_f32 v69, v146, v147
    ds_read_b128 v[56:59], v19 offset:4096
    v_cvt_pk_bf16_f32 v70, v148, v149
    v_cvt_pk_bf16_f32 v71, v150, v151
    v_mfma_f32_16x16x32_bf16 v[196:199], v[228:231], v[84:87], v[196:199]
    v_exp_f32 v152, v152
    v_exp_f32 v153, v153
    ds_read_b128 v[60:63], v19 offset:6144
    v_exp_f32 v154, v154
    v_exp_f32 v155, v155
    s_waitcnt lgkmcnt(5)
    v_mfma_f32_16x16x32_bf16 v[168:171], v[48:51], v[104:107], v[168:171]
    v_exp_f32 v156, v156
    s_waitcnt lgkmcnt(3)
    v_mfma_f32_16x16x32_bf16 v[172:175], v[48:51], v[108:111], v[172:175]
    v_exp_f32 v157, v157
    v_exp_f32 v158, v158
    s_waitcnt lgkmcnt(2)
    v_mfma_f32_16x16x32_bf16 v[176:179], v[52:55], v[104:107], v[176:179]
    v_exp_f32 v159, v159
    v_cvt_pk_bf16_f32 v72, v152, v153
K1_hop1260:
    s_cbranch_execz K1_ret
    v_mfma_f32_16x16x32_bf16 v[180:183], v[52:55], v[108:111], v[180:183]
    v_cvt_pk_bf16_f32 v73, v154, v155
    v_cvt_pk_bf16_f32 v74, v156, v157
    s_waitcnt lgkmcnt(1)
    v_mfma_f32_16x16x32_bf16 v[184:187], v[56:59], v[104:107], v[184:187]
    v_cvt_pk_bf16_f32 v75, v158, v159
    v_mfma_f32_16x16x32_bf16 v[112:115], v[212:215], v[64:67], 0
    v_mfma_f32_16x16x32_bf16 v[188:191], v[56:59], v[108:111], v[188:191]
    v_mfma_f32_16x16x32_bf16 v[116:119], v[212:215], v[68:71], 0
    v_mfma_f32_16x16x32_bf16 v[120:123], v[212:215], v[72:75], 0
    s_waitcnt lgkmcnt(0)
    v_mfma_f32_16x16x32_bf16 v[192:195], v[60:63], v[104:107], v[192:195]
    s_nop 2
    v_rcp_f32 v112, v112
    s_nop 0
    v_rcp_f32 v116, v116
    v_mfma_f32_16x16x32_bf16 v[196:199], v[60:63], v[108:111], v[196:199]
    v_rcp_f32 v120, v120
    v_cvt_pk_bf16_f32 v32, v168, v169
K1_hop1279:
    s_cbranch_execz K1_ret
    v_cvt_pk_bf16_f32 v33, v170, v171
    v_cvt_pk_bf16_f32 v40, v172, v173
    v_cvt_pk_bf16_f32 v41, v174, v175
    v_cvt_pk_bf16_f32 v34, v176, v177
    v_cvt_pk_bf16_f32 v35, v178, v179
    v_cvt_pk_bf16_f32 v42, v180, v181
    v_cvt_pk_bf16_f32 v43, v182, v183
    v_mfma_f32_16x16x32_bf16 v[136:139], v[32:35], v[64:67], 0
    s_nop 0
    v_mfma_f32_16x16x32_bf16 v[140:143], v[40:43], v[64:67], 0
    v_cvt_pk_bf16_f32 v36, v184, v185
    v_cvt_pk_bf16_f32 v37, v186, v187
    v_cvt_pk_bf16_f32 v44, v188, v189
    v_cvt_pk_bf16_f32 v45, v190, v191
    v_mfma_f32_16x16x32_bf16 v[144:147], v[34:37], v[68:71], 0
    s_nop 0
    v_mfma_f32_16x16x32_bf16 v[148:151], v[42:45], v[68:71], 0
K1_hop1296:
    s_cbranch_execz K1_ret
    v_cvt_pk_bf16_f32 v38, v192, v193
    v_cvt_pk_bf16_f32 v39, v194, v195
    v_cvt_pk_bf16_f32 v46, v196, v197
    v_cvt_pk_bf16_f32 v47, v198, v199
    v_mfma_f32_16x16x32_bf16 v[152:155], v[36:39], v[72:75], 0
    s_nop 0
    v_mfma_f32_16x16x32_bf16 v[156:159], v[44:47], v[72:75], 0
    v_mul_f32 v136, v136, v112
    v_mul_f32 v137, v137, v112
    v_mul_f32 v138, v138, v112
    v_mul_f32 v139, v139, v112
    v_cvt_pk_bf16_f32 v88, v136, v137
    v_cvt_pk_bf16_f32 v89, v138, v139
    v_mul_f32 v140, v140, v112
    v_mul_f32 v141, v141, v112
    v_mul_f32 v142, v142, v112
    v_mul_f32 v143, v143, v112
    v_cvt_pk_bf16_f32 v90, v140, v141
    v_cvt_pk_bf16_f32 v91, v142, v143
    s_nop 0
K1_hop1316:
    s_cbranch_execz K1_ret
    v_permlane16_swap_b32 v88, v90
    v_permlane16_swap_b32 v89, v91
    buffer_store_dwordx4 v[88:91], v12, s[12:15], s45 offen
    buffer_store_dwordx2 v[88:89], v13, s[12:15], s45 offen
    v_mul_f32 v144, v144, v116
    v_mul_f32 v145, v145, v116
    v_mul_f32 v146, v146, v116
    v_mul_f32 v147, v147, v116
    v_cvt_pk_bf16_f32 v92, v144, v145
    v_cvt_pk_bf16_f32 v93, v146, v147
    v_mul_f32 v148, v148, v116
    v_mul_f32 v149, v149, v116
    v_mul_f32 v150, v150, v116
    v_mul_f32 v151, v151, v116
    v_cvt_pk_bf16_f32 v94, v148, v149
    v_cvt_pk_bf16_f32 v95, v150, v151
    s_nop 0
    v_permlane16_swap_b32 v92, v94
    v_permlane16_swap_b32 v93, v95
    buffer_store_dwordx4 v[92:95], v12, s[12:15], s46 offen
    buffer_store_dwordx2 v[92:93], v13, s[12:15], s46 offen
    v_mul_f32 v152, v152, v120
    v_mul_f32 v153, v153, v120
K1_hop1339:
    s_cbranch_execz K1_ret
    v_mul_f32 v154, v154, v120
    v_mul_f32 v155, v155, v120
    v_cvt_pk_bf16_f32 v96, v152, v153
    v_cvt_pk_bf16_f32 v97, v154, v155
    v_mul_f32 v156, v156, v120
    v_mul_f32 v157, v157, v120
    v_mul_f32 v158, v158, v120
    v_mul_f32 v159, v159, v120
    v_cvt_pk_bf16_f32 v98, v156, v157
    v_cvt_pk_bf16_f32 v99, v158, v159
    s_nop 0
    v_permlane16_swap_b32 v96, v98
    v_permlane16_swap_b32 v97, v99
    buffer_store_dwordx4 v[96:99], v12, s[12:15], s47 offen
    buffer_store_dwordx2 v[96:97], v13, s[12:15], s47 offen
    s_endpgm
K1_spec:
    s_waitcnt lgkmcnt(0)
    s_mov_b32 s4, s92
    s_mov_b32 s5, s93
    s_mov_b32 s6, 0x1c0000
    s_mov_b32 s7, 0x20000
    s_mov_b32 s8, s94
    s_mov_b32 s9, s95
    s_mov_b32 s10, 0x126000
    s_mov_b32 s11, 0x20000
    s_add_u32 s16, s90, 0x200000
    s_addc_u32 s17, s91, 0
    s_mov_b32 s18, 0x100000
    s_mov_b32 s19, 0x20000
    s_cmp_lt_u32 s24, 4
    s_cbranch_scc1 K1_spec2
    s_sub_u32 s27, s26, 22
    s_lshl_b32 s27, s27, 1
    s_and_b32 s28, s24, 1
    s_add_u32 s27, s27, s28
    s_lshl_b32 s27, s27, 6
    v_add_u32 v6, s27, v0
    s_movk_i32 s34, 896
    v_mov_b32 v16, 0x80000000
    s_cmp_ge_u32 s24, 6
    s_cbranch_scc1 K1_pfx
    s_and_b32 s28, s25, 1
    s_mul_i32 s28, s28, 384
    s_movk_i32 s33, 2688
    v_bfe_u32 v7, v0, 2, 2
    v_and_b32 v8, 3, v0
    v_lshlrev_b32 v8, 7, v8
    v_add_u32 v8, s28, v8
    v_cmp_gt_u32 vcc, 3, v7
    v_mad_u32_u24 v7, v7, s34, v8
    s_nop 0
    v_cndmask_b32 v7, v16, v7, vcc
    v_lshrrev_b32 v10, 4, v6
    v_mad_u32_u24 v12, v10, s33, v7
    s_mov_b32 s28, 172032
    buffer_load_dword v21, v12, s[8:11], s28 offen
    s_mov_b32 s28, 344064
    buffer_load_dword v22, v12, s[8:11], s28 offen
    s_waitcnt vmcnt(1)
    s_mov_b32 s28, 516096
    buffer_load_dword v23, v12, s[8:11], s28 offen
    s_waitcnt vmcnt(1)
    s_mov_b32 s28, 688128
    buffer_load_dword v24, v12, s[8:11], s28 offen
    s_waitcnt vmcnt(1)
    s_mov_b32 s28, 860160
    buffer_load_dword v25, v12, s[8:11], s28 offen
    s_waitcnt vmcnt(1)
    s_mov_b32 s28, 1032192
    buffer_load_dword v26, v12, s[8:11], s28 offen
    s_waitcnt vmcnt(0)
    s_mov_b64 exec, 0
    s_and_b32 s23, s24, 3
    s_cmp_eq_u32 s23, 0
    s_cbranch_scc1 K2_seg0
    s_cmp_eq_u32 s23, 1
    s_cbranch_scc1 K2_seg1
    s_cmp_eq_u32 s23, 2
    s_cbranch_scc1 K2_seg2
    s_branch K2_seg3
K1_pfx:
    s_cmp_ge_u32 s27, 592
    s_cbranch_scc1 K1_pfe
    s_lshr_b32 s29, s25, 1
    s_mul_i32 s29, s29, 22
    s_lshr_b32 s29, s29, 2
    s_mul_i32 s29, s29, 96
    s_sub_u32 s29, s29, 16
    s_max_i32 s29, s29, 0
    v_cmp_gt_u32 vcc, 592, v6
    v_add_u32 v10, s29, v6
    v_mul_u32_u24 v10, s34, v10
    v_cndmask_b32 v12, v16, v10, vcc
    buffer_load_dword v21, v12, s[4:7], 0 offen offset:128
    buffer_load_dword v22, v12, s[4:7], 0 offen offset:256
    s_waitcnt vmcnt(1)
    buffer_load_dword v23, v12, s[4:7], 0 offen offset:384
    s_waitcnt vmcnt(1)
    buffer_load_dword v24, v12, s[4:7], 0 offen offset:512
    s_waitcnt vmcnt(1)
    buffer_load_dword v25, v12, s[4:7], 0 offen offset:640
    s_waitcnt vmcnt(1)
    buffer_load_dword v26, v12, s[4:7], 0 offen offset:768
    s_waitcnt vmcnt(0)
K1_pfe:
    s_mov_b64 exec, 0
    s_and_b32 s23, s24, 3
    s_cmp_eq_u32 s23, 0
    s_cbranch_scc1 K2_seg0
    s_cmp_eq_u32 s23, 1
    s_cbranch_scc1 K2_seg1
    s_cmp_eq_u32 s23, 2
    s_cbranch_scc1 K2_seg2
    s_branch K2_seg3
K1_spec2:
    s_sub_u32 s27, s26, 22
    s_and_b32 s28, s27, 1
    s_lshr_b32 s27, s27, 1
    s_lshl_b32 s29, s25, 2
    s_add_u32 s27, s27, s29
    s_lshl_b32 s28, s28, 8
    s_lshl_b32 s29, s24, 2
    v_add_u32 v6, s29, v3
    v_lshlrev_b32 v7, 5, v6
    v_add_u32 v7, s27, v7
    s_movk_i32 s33, 896
    v_lshlrev_b32 v8, 4, v2
    v_add_u32 v8, s28, v8
    v_sub_u32 v9, 880, v8
    v_add_u32 v18, 0, v7
    v_sub_u32 v19, 2048, v18
    v_and_b32 v19, 2047, v19
    v_mad_u32_u24 v18, v18, s33, v8
    v_mad_u32_u24 v19, v19, s33, v9
    buffer_load_dwordx4 v[32:35], v18, s[4:7], 0 offen
    buffer_load_dwordx4 v[36:39], v19, s[4:7], 0 offen
    buffer_load_dword v40, v19, s[4:7], 0 offen offset:16
    v_add_u32 v18, 512, v7
    v_sub_u32 v19, 2048, v18
    v_and_b32 v19, 2047, v19
    v_mad_u32_u24 v18, v18, s33, v8
    v_mad_u32_u24 v19, v19, s33, v9
    buffer_load_dwordx4 v[42:45], v18, s[4:7], 0 offen
    buffer_load_dwordx4 v[46:49], v19, s[4:7], 0 offen
    buffer_load_dword v50, v19, s[4:7], 0 offen offset:16
    v_add_u32 v18, 1024, v7
    v_sub_u32 v19, 2048, v18
    v_and_b32 v19, 2047, v19
    v_mad_u32_u24 v18, v18, s33, v8
    v_mad_u32_u24 v19, v19, s33, v9
    buffer_load_dwordx4 v[52:55], v18, s[4:7], 0 offen
    buffer_load_dwordx4 v[56:59], v19, s[4:7], 0 offen
    buffer_load_dword v60, v19, s[4:7], 0 offen offset:16
    v_add_u32 v18, 1536, v7
    v_sub_u32 v19, 2048, v18
    v_and_b32 v19, 2047, v19
    v_mad_u32_u24 v18, v18, s33, v8
    v_mad_u32_u24 v19, v19, s33, v9
    buffer_load_dwordx4 v[62:65], v18, s[4:7], 0 offen
    buffer_load_dwordx4 v[66:69], v19, s[4:7], 0 offen
    buffer_load_dword v70, v19, s[4:7], 0 offen offset:16
    v_lshrrev_b32 v10, 1, v2
    s_lshl_b32 s29, s24, 3
    v_add_u32 v10, s29, v10
    v_and_b32 v11, 1, v2
    v_lshlrev_b32 v16, 15, v10
    v_lshl_add_u32 v16, v11, 12, v16
    v_lshl_add_u32 v16, v3, 4, v16
    s_lshl_b32 s29, s27, 7
    s_lshl_b32 s30, s28, 6
    s_add_u32 s29, s29, s30
    v_add_u32 v16, s29, v16
    v_cvt_f32_u32 v12, v10
    v_cvt_f32_u32 v13, v11
    v_cvt_f32_u32 v14, s27
    v_mul_f32 v14, v14, v12
    v_mul_f32 v14, 0x3a000000, v14
    v_fmac_f32 v14, 0x3e800000, v13
    v_mul_f32 v12, 0x3c800000, v12
    v_lshl_add_u32 v10, v10, 1, v11
    v_cmp_eq_u32 vcc, 1, v10
    v_mov_b32 v15, 0.5
    s_nop 0
    v_cndmask_b32 v12, v12, v15, vcc
    v_mov_b32 v15, 0
    v_cndmask_b32 v14, v14, v15, vcc
    v_lshlrev_b32 v15, 3, v3
    v_cvt_f32_u32 v15, v15
    v_fmac_f32 v14, v15, v12
    v_mov_b32 v20, 0x0
    v_fma_f32 v20, v20, v12, v14
    v_mov_b32 v21, 0x3f800000
    v_fma_f32 v21, v21, v12, v14
    v_mov_b32 v22, 0x40000000
    v_fma_f32 v22, v22, v12, v14
    v_mov_b32 v23, 0x40400000
    v_fma_f32 v23, v23, v12, v14
    v_mov_b32 v24, 0x40800000
    v_fma_f32 v24, v24, v12, v14
    v_mov_b32 v25, 0x40a00000
    v_fma_f32 v25, v25, v12, v14
    v_mov_b32 v26, 0x40c00000
    v_fma_f32 v26, v26, v12, v14
    v_mov_b32 v27, 0x40e00000
    v_fma_f32 v27, v27, v12, v14
    v_fract_f32 v20, v20
    v_fract_f32 v21, v21
    v_fract_f32 v22, v22
    v_fract_f32 v23, v23
    v_fract_f32 v24, v24
    v_fract_f32 v25, v25
    v_fract_f32 v26, v26
    v_fract_f32 v27, v27
    v_cos_f32 v20, v20
    v_cos_f32 v21, v21
    v_cos_f32 v22, v22
    v_cos_f32 v23, v23
    v_cos_f32 v24, v24
    v_cos_f32 v25, v25
    v_cos_f32 v26, v26
    v_cos_f32 v27, v27
    v_cvt_pk_bf16_f32 v80, v20, v21
    v_cvt_pk_bf16_f32 v81, v22, v23
    v_cvt_pk_bf16_f32 v82, v24, v25
    v_cvt_pk_bf16_f32 v83, v26, v27
    v_mov_b32 v20, 0x42000000
    v_fma_f32 v20, v20, v12, v14
    v_mov_b32 v21, 0x42040000
    v_fma_f32 v21, v21, v12, v14
    v_mov_b32 v22, 0x42080000
    v_fma_f32 v22, v22, v12, v14
    v_mov_b32 v23, 0x420c0000
    v_fma_f32 v23, v23, v12, v14
    v_mov_b32 v24, 0x42100000
    v_fma_f32 v24, v24, v12, v14
    v_mov_b32 v25, 0x42140000
    v_fma_f32 v25, v25, v12, v14
    v_mov_b32 v26, 0x42180000
    v_fma_f32 v26, v26, v12, v14
    v_mov_b32 v27, 0x421c0000
    v_fma_f32 v27, v27, v12, v14
    v_fract_f32 v20, v20
    v_fract_f32 v21, v21
    v_fract_f32 v22, v22
    v_fract_f32 v23, v23
    v_fract_f32 v24, v24
    v_fract_f32 v25, v25
    v_fract_f32 v26, v26
    v_fract_f32 v27, v27
    v_cos_f32 v20, v20
    v_cos_f32 v21, v21
    v_cos_f32 v22, v22
    v_cos_f32 v23, v23
    v_cos_f32 v24, v24
    v_cos_f32 v25, v25
    v_cos_f32 v26, v26
    v_cos_f32 v27, v27
    v_cvt_pk_bf16_f32 v84, v20, v21
    v_cvt_pk_bf16_f32 v85, v22, v23
    v_cvt_pk_bf16_f32 v86, v24, v25
    v_cvt_pk_bf16_f32 v87, v26, v27
    v_cmp_ne_u32 vcc, 0, v8
    v_and_b32 v10, 3, v6
    v_lshlrev_b32 v10, 2, v10
    v_xor_b32 v10, v2, v10
    v_lshlrev_b32 v10, 4, v10
    v_lshl_add_u32 v10, v6, 8, v10
    v_bfe_u32 v11, v0, 2, 2
    v_lshl_add_u32 v12, v3, 3, v11
    v_lshlrev_b32 v12, 8, v12
    v_and_b32 v13, 3, v0
    v_lshl_add_u32 v12, v13, 4, v12
    v_lshlrev_b32 v11, 6, v11
    v_xor_b32 v4, 0, v11
    v_add_u32 v4, v4, v12
    v_xor_b32 v5, 64, v11
    v_add_u32 v5, v5, v12
    v_xor_b32 v6, 128, v11
    v_add_u32 v6, v6, v12
    v_xor_b32 v7, 192, v11
    v_add_u32 v7, v7, v12
    s_waitcnt vmcnt(9)
    v_cndmask_b32 v40, 0, v40, vcc
    v_lshlrev_b32 v20, 16, v32
    v_and_b32 v21, 0xffff0000, v32
    v_lshlrev_b32 v22, 16, v40
    v_and_b32 v23, 0xffff0000, v39
    v_add_f32 v20, v20, v22
    v_add_f32 v21, v21, v23
    v_cvt_pk_bf16_f32 v24, v20, v21
    v_lshlrev_b32 v20, 16, v33
    v_and_b32 v21, 0xffff0000, v33
    v_lshlrev_b32 v22, 16, v39
    v_and_b32 v23, 0xffff0000, v38
    v_add_f32 v20, v20, v22
    v_add_f32 v21, v21, v23
    v_cvt_pk_bf16_f32 v25, v20, v21
    v_lshlrev_b32 v20, 16, v34
    v_and_b32 v21, 0xffff0000, v34
    v_lshlrev_b32 v22, 16, v38
    v_and_b32 v23, 0xffff0000, v37
    v_add_f32 v20, v20, v22
    v_add_f32 v21, v21, v23
    v_cvt_pk_bf16_f32 v26, v20, v21
    v_lshlrev_b32 v20, 16, v35
    v_and_b32 v21, 0xffff0000, v35
    v_lshlrev_b32 v22, 16, v37
    v_and_b32 v23, 0xffff0000, v36
    v_add_f32 v20, v20, v22
    v_add_f32 v21, v21, v23
    v_cvt_pk_bf16_f32 v27, v20, v21
    ds_write_b128 v10, v[24:27] offset:0
    s_waitcnt vmcnt(6)
    v_cndmask_b32 v50, 0, v50, vcc
    v_lshlrev_b32 v20, 16, v42
    v_and_b32 v21, 0xffff0000, v42
    v_lshlrev_b32 v22, 16, v50
    v_and_b32 v23, 0xffff0000, v49
    v_add_f32 v20, v20, v22
    v_add_f32 v21, v21, v23
    v_cvt_pk_bf16_f32 v24, v20, v21
    v_lshlrev_b32 v20, 16, v43
    v_and_b32 v21, 0xffff0000, v43
    v_lshlrev_b32 v22, 16, v49
    v_and_b32 v23, 0xffff0000, v48
    v_add_f32 v20, v20, v22
    v_add_f32 v21, v21, v23
    v_cvt_pk_bf16_f32 v25, v20, v21
    v_lshlrev_b32 v20, 16, v44
    v_and_b32 v21, 0xffff0000, v44
    v_lshlrev_b32 v22, 16, v48
    v_and_b32 v23, 0xffff0000, v47
    v_add_f32 v20, v20, v22
    v_add_f32 v21, v21, v23
    v_cvt_pk_bf16_f32 v26, v20, v21
    v_lshlrev_b32 v20, 16, v45
    v_and_b32 v21, 0xffff0000, v45
    v_lshlrev_b32 v22, 16, v47
    v_and_b32 v23, 0xffff0000, v46
    v_add_f32 v20, v20, v22
    v_add_f32 v21, v21, v23
    v_cvt_pk_bf16_f32 v27, v20, v21
    ds_write_b128 v10, v[24:27] offset:4096
    s_waitcnt vmcnt(3)
    v_cndmask_b32 v60, 0, v60, vcc
    v_lshlrev_b32 v20, 16, v52
    v_and_b32 v21, 0xffff0000, v52
    v_lshlrev_b32 v22, 16, v60
    v_and_b32 v23, 0xffff0000, v59
    v_add_f32 v20, v20, v22
    v_add_f32 v21, v21, v23
    v_cvt_pk_bf16_f32 v24, v20, v21
    v_lshlrev_b32 v20, 16, v53
    v_and_b32 v21, 0xffff0000, v53
    v_lshlrev_b32 v22, 16, v59
    v_and_b32 v23, 0xffff0000, v58
    v_add_f32 v20, v20, v22
    v_add_f32 v21, v21, v23
    v_cvt_pk_bf16_f32 v25, v20, v21
    v_lshlrev_b32 v20, 16, v54
    v_and_b32 v21, 0xffff0000, v54
    v_lshlrev_b32 v22, 16, v58
    v_and_b32 v23, 0xffff0000, v57
    v_add_f32 v20, v20, v22
    v_add_f32 v21, v21, v23
    v_cvt_pk_bf16_f32 v26, v20, v21
    v_lshlrev_b32 v20, 16, v55
    v_and_b32 v21, 0xffff0000, v55
    v_lshlrev_b32 v22, 16, v57
    v_and_b32 v23, 0xffff0000, v56
    v_add_f32 v20, v20, v22
    v_add_f32 v21, v21, v23
    v_cvt_pk_bf16_f32 v27, v20, v21
    ds_write_b128 v10, v[24:27] offset:8192
    s_waitcnt vmcnt(0)
    v_cndmask_b32 v70, 0, v70, vcc
    v_lshlrev_b32 v20, 16, v62
    v_and_b32 v21, 0xffff0000, v62
    v_lshlrev_b32 v22, 16, v70
    v_and_b32 v23, 0xffff0000, v69
    v_add_f32 v20, v20, v22
    v_add_f32 v21, v21, v23
    v_cvt_pk_bf16_f32 v24, v20, v21
    v_lshlrev_b32 v20, 16, v63
    v_and_b32 v21, 0xffff0000, v63
    v_lshlrev_b32 v22, 16, v69
    v_and_b32 v23, 0xffff0000, v68
    v_add_f32 v20, v20, v22
    v_add_f32 v21, v21, v23
    v_cvt_pk_bf16_f32 v25, v20, v21
    v_lshlrev_b32 v20, 16, v64
    v_and_b32 v21, 0xffff0000, v64
    v_lshlrev_b32 v22, 16, v68
    v_and_b32 v23, 0xffff0000, v67
    v_add_f32 v20, v20, v22
    v_add_f32 v21, v21, v23
    v_cvt_pk_bf16_f32 v26, v20, v21
    v_lshlrev_b32 v20, 16, v65
    v_and_b32 v21, 0xffff0000, v65
    v_lshlrev_b32 v22, 16, v67
    v_and_b32 v23, 0xffff0000, v66
    v_add_f32 v20, v20, v22
    v_add_f32 v21, v21, v23
    v_cvt_pk_bf16_f32 v27, v20, v21
    ds_write_b128 v10, v[24:27] offset:12288
    s_waitcnt lgkmcnt(0)
    s_barrier
    ds_read_b64_tr_b16 v[96:97], v4 offset:0
    ds_read_b64_tr_b16 v[98:99], v4 offset:1024
    ds_read_b64_tr_b16 v[100:101], v4 offset:8192
    ds_read_b64_tr_b16 v[102:103], v4 offset:9216
    ds_read_b64_tr_b16 v[104:105], v4 offset:8
    ds_read_b64_tr_b16 v[106:107], v4 offset:1032
    ds_read_b64_tr_b16 v[108:109], v4 offset:8200
    ds_read_b64_tr_b16 v[110:111], v4 offset:9224
    ds_read_b64_tr_b16 v[112:113], v5 offset:0
    ds_read_b64_tr_b16 v[114:115], v5 offset:1024
    ds_read_b64_tr_b16 v[116:117], v5 offset:8192
    ds_read_b64_tr_b16 v[118:119], v5 offset:9216
    ds_read_b64_tr_b16 v[120:121], v5 offset:8
    ds_read_b64_tr_b16 v[122:123], v5 offset:1032
    ds_read_b64_tr_b16 v[124:125], v5 offset:8200
    ds_read_b64_tr_b16 v[126:127], v5 offset:9224
    ds_read_b64_tr_b16 v[128:129], v6 offset:0
    ds_read_b64_tr_b16 v[130:131], v6 offset:1024
    ds_read_b64_tr_b16 v[132:133], v6 offset:8192
    ds_read_b64_tr_b16 v[134:135], v6 offset:9216
    ds_read_b64_tr_b16 v[136:137], v6 offset:8
    ds_read_b64_tr_b16 v[138:139], v6 offset:1032
    ds_read_b64_tr_b16 v[140:141], v6 offset:8200
    ds_read_b64_tr_b16 v[142:143], v6 offset:9224
    ds_read_b64_tr_b16 v[144:145], v7 offset:0
    ds_read_b64_tr_b16 v[146:147], v7 offset:1024
    ds_read_b64_tr_b16 v[148:149], v7 offset:8192
    ds_read_b64_tr_b16 v[150:151], v7 offset:9216
    ds_read_b64_tr_b16 v[152:153], v7 offset:8
    ds_read_b64_tr_b16 v[154:155], v7 offset:1032
    ds_read_b64_tr_b16 v[156:157], v7 offset:8200
    ds_read_b64_tr_b16 v[158:159], v7 offset:9224
    s_waitcnt lgkmcnt(15)
    v_mfma_f32_16x16x32_bf16 v[32:35], v[96:99], v[80:83], 0
    v_mfma_f32_16x16x32_bf16 v[36:39], v[104:107], v[80:83], 0
    v_mfma_f32_16x16x32_bf16 v[32:35], v[100:103], v[84:87], v[32:35]
    v_mfma_f32_16x16x32_bf16 v[36:39], v[108:111], v[84:87], v[36:39]
    s_waitcnt lgkmcnt(15)
    v_mfma_f32_16x16x32_bf16 v[40:43], v[112:115], v[80:83], 0
    v_mfma_f32_16x16x32_bf16 v[44:47], v[120:123], v[80:83], 0
    v_mfma_f32_16x16x32_bf16 v[40:43], v[116:119], v[84:87], v[40:43]
    v_mfma_f32_16x16x32_bf16 v[44:47], v[124:127], v[84:87], v[44:47]
    s_waitcnt lgkmcnt(8)
    v_mfma_f32_16x16x32_bf16 v[48:51], v[128:131], v[80:83], 0
    v_mfma_f32_16x16x32_bf16 v[52:55], v[136:139], v[80:83], 0
    v_mfma_f32_16x16x32_bf16 v[48:51], v[132:135], v[84:87], v[48:51]
    v_mfma_f32_16x16x32_bf16 v[52:55], v[140:143], v[84:87], v[52:55]
    s_waitcnt lgkmcnt(0)
    v_mfma_f32_16x16x32_bf16 v[56:59], v[144:147], v[80:83], 0
    v_mfma_f32_16x16x32_bf16 v[60:63], v[152:155], v[80:83], 0
    v_mfma_f32_16x16x32_bf16 v[56:59], v[148:151], v[84:87], v[56:59]
    v_mfma_f32_16x16x32_bf16 v[60:63], v[156:159], v[84:87], v[60:63]
    v_cvt_pk_bf16_f32 v64, v32, v33
    v_cvt_pk_bf16_f32 v65, v34, v35
    v_cvt_pk_bf16_f32 v66, v36, v37
    v_cvt_pk_bf16_f32 v67, v38, v39
    buffer_store_dwordx4 v[64:67], v16, s[16:19], 0 offen offset:0 sc1
    v_cvt_pk_bf16_f32 v68, v40, v41
    v_cvt_pk_bf16_f32 v69, v42, v43
    v_cvt_pk_bf16_f32 v70, v44, v45
    v_cvt_pk_bf16_f32 v71, v46, v47
    buffer_store_dwordx4 v[68:71], v16, s[16:19], 0 offen offset:64 sc1
    v_cvt_pk_bf16_f32 v72, v48, v49
    v_cvt_pk_bf16_f32 v73, v50, v51
    v_cvt_pk_bf16_f32 v74, v52, v53
    v_cvt_pk_bf16_f32 v75, v54, v55
    v_add_u32 v16, 8192, v16
    buffer_store_dwordx4 v[72:75], v16, s[16:19], 0 offen offset:0 sc1
    v_cvt_pk_bf16_f32 v76, v56, v57
    v_cvt_pk_bf16_f32 v77, v58, v59
    v_cvt_pk_bf16_f32 v78, v60, v61
    v_cvt_pk_bf16_f32 v79, v62, v63
    buffer_store_dwordx4 v[76:79], v16, s[16:19], 0 offen offset:64 sc1
    s_mov_b32 s40, s60
    s_mov_b32 s41, s61
    s_mov_b32 s42, 0x62000
    s_mov_b32 s43, 0x20000
    s_sub_u32 s27, s26, 22
    s_lshl_b32 s27, s27, 2
    s_add_u32 s27, s27, s24
    s_lshl_b32 s27, s27, 14
    v_lshl_add_u32 v1, v0, 7, s27
    v_add_u32 v2, 8192, v1
    buffer_load_dword v4, v2, s[40:43], 0 offen
    buffer_load_dword v3, v1, s[40:43], 0 offen
    s_waitcnt vmcnt(0)
    s_endpgm
K1_end:
    s_endpgm
.globl fnet_k2_kernel
.p2align 8
.type fnet_k2_kernel,@function
fnet_k2_kernel:
K2_seg0:
K2_hop0:
    s_cbranch_execz K2_hop1
    s_and_b32 s25, s2, 7
    s_lshr_b32 s26, s2, 3
    s_mul_i32 s25, s25, 29
    s_add_u32 s25, s25, s26
    s_cmp_ge_u32 s2, 232
    s_cbranch_scc1 K2_end
    s_cmp_ge_u32 s25, 231
    s_cbranch_scc1 K2_end
    s_load_dwordx2 s[92:93], s[0:1], 56
    s_load_dwordx2 s[94:95], s[0:1], 72
    s_load_dwordx2 s[90:91], s[0:1], 88
    s_mul_i32 s27, s25, 9363
    s_lshr_b32 s27, s27, 16
    s_mul_i32 s28, s27, 7
    s_sub_u32 s28, s25, s28
    v_lshrrev_b32 v1, 6, v0
    v_and_b32 v0, 63, v0
    v_readfirstlane_b32 s24, v1
    v_and_b32 v2, 15, v0
    v_lshrrev_b32 v3, 4, v0
    v_lshrrev_b32 v4, 3, v0
    v_and_b32 v5, 7, v0
    s_and_b32 s33, s27, 31
    s_cmp_eq_u32 s33, 0
    s_cselect_b32 s34, 0x80000000, 0
K2_hop1:
    s_cbranch_execz K2_hop2
    s_movk_i32 s33, 896
    s_lshl_b32 s30, s28, 7
    s_cmp_eq_u32 s27, 32
    s_cselect_b32 s37, 1, 0
    s_cmp_lt_u32 s24, 4
    s_cbranch_scc1 K2_comp
    s_and_b32 s23, s24, 3
    s_and_b32 s29, s24, 1
    s_lshl_b32 s29, s29, 2
    v_add_u32 v6, s29, v3
    v_xor_b32 v6, v5, v6
    v_and_b32 v6, 7, v6
    v_lshlrev_b32 v6, 4, v6
    s_lshl_b32 s31, s23, 3
    v_add_u32 v7, s31, v4
    v_lshl_add_u32 v13, v7, 7, v6
    s_lshl_b32 s31, s27, 15
    s_cmp_eq_u32 s27, 32
    s_cselect_b32 s32, 4096, s31
    v_add_u32 v8, s32, v13
    s_add_u32 s31, s31, 4096
    s_or_b32 s31, s31, s34
    v_add_u32 v9, s31, v13
    v_lshlrev_b32 v13, 6, v7
    v_add_u32 v13, s27, v13
    v_mad_u32_u24 v10, v13, s33, v6
K2_hop2:
    s_cbranch_execz K2_hop3
    v_mul_u32_u24 v14, 128, v7
    v_add_u32 v10, v10, v14
    v_sub_u32 v13, 2048, v13
    v_mad_u32_u24 v11, v13, s33, v6
    v_lshrrev_b32 v14, 6, v13
    v_mul_u32_u24 v14, 128, v14
    v_add_u32 v11, v11, v14
    v_or_b32 v11, s34, v11
    v_and_b32 v6, 1, v3
    v_lshlrev_b32 v6, 1, v6
    v_add_u32 v6, s29, v6
    v_xor_b32 v6, v5, v6
    v_lshlrev_b32 v6, 4, v6
    v_add_u32 v6, s30, v6
    v_mad_u32_u24 v12, v7, s33, v6
    v_add_u32 v13, 28672, v12
    s_lshl_b32 s35, s23, 10
    s_waitcnt lgkmcnt(0)
    s_add_u32 s16, s90, 0x200000
    s_addc_u32 s17, s91, 0
    s_mov_b32 s18, 0x100000
    s_mov_b32 s19, 0x20000
K2_hop3:
    s_cbranch_execz K2_hop4
    s_mov_b32 s12, s90
    s_mov_b32 s13, s91
    s_mov_b32 s14, 0x200000
    s_mov_b32 s15, 0x20000
    s_mov_b32 s8, s92
    s_mov_b32 s9, s93
    s_mov_b32 s10, 0x62000
    s_mov_b32 s11, 0x20000
    s_add_u32 m0, s35, 0
    s_movk_i32 s36, 0
    buffer_load_dwordx4 v8, s[16:19], s36 offen lds
    s_add_u32 m0, s35, 4096
    s_movk_i32 s36, 0
    buffer_load_dwordx4 v9, s[16:19], s36 offen lds
    s_add_u32 m0, s35, 8192
    s_movk_i32 s36, 8192
    buffer_load_dwordx4 v8, s[16:19], s36 offen lds
    s_add_u32 m0, s35, 12288
    s_movk_i32 s36, 8192
    buffer_load_dwordx4 v9, s[16:19], s36 offen lds
K2_hop4:
    s_cbranch_execz K2_hop5
    s_add_u32 m0, s35, 16384
    s_movk_i32 s36, 16384
    buffer_load_dwordx4 v8, s[16:19], s36 offen lds
    s_add_u32 m0, s35, 20480
    s_movk_i32 s36, 16384
    buffer_load_dwordx4 v9, s[16:19], s36 offen lds
    s_add_u32 m0, s35, 24576
    s_movk_i32 s36, 24576
    buffer_load_dwordx4 v8, s[16:19], s36 offen lds
    s_add_u32 m0, s35, 28672
    s_movk_i32 s36, 24576
    buffer_load_dwordx4 v9, s[16:19], s36 offen lds
    s_add_u32 m0, s35, 32768
    s_nop 0
    buffer_load_dwordx4 v10, s[12:15], 0 offen offset:0 lds
    s_add_u32 m0, s35, 40960
    s_mov_b32 s36, 0
    buffer_load_dwordx4 v12, s[8:11], s36 offen lds
    s_add_u32 m0, s35, 36864
K2_hop5:
    s_cbranch_execz K2_hop6
    s_nop 0
    buffer_load_dwordx4 v11, s[12:15], 0 offen offset:0 lds
    s_add_u32 m0, s35, 45056
    s_nop 0
    buffer_load_dwordx4 v13, s[8:11], s36 offen lds
    s_add_u32 m0, s35, 49024
    s_nop 0
    buffer_load_dwordx4 v10, s[12:15], 0 offen offset:128 lds
    s_add_u32 m0, s35, 57344
    s_mov_b32 s36, 57344
    buffer_load_dwordx4 v12, s[8:11], s36 offen lds
    s_add_u32 m0, s35, 53120
    s_nop 0
    buffer_load_dwordx4 v11, s[12:15], 0 offen offset:128 lds
    s_add_u32 m0, s35, 61440
    s_nop 0
    buffer_load_dwordx4 v13, s[8:11], s36 offen lds
    s_add_u32 m0, s35, 65280
K2_hop6:
    s_cbranch_execz K2_hop7
    s_nop 0
    buffer_load_dwordx4 v10, s[12:15], 0 offen offset:256 lds
    s_add_u32 m0, s35, 73728
    s_mov_b32 s36, 114688
    buffer_load_dwordx4 v12, s[8:11], s36 offen lds
    s_add_u32 m0, s35, 69376
    s_nop 0
    buffer_load_dwordx4 v11, s[12:15], 0 offen offset:256 lds
    s_add_u32 m0, s35, 77824
    s_nop 0
    buffer_load_dwordx4 v13, s[8:11], s36 offen lds
    s_waitcnt vmcnt(12)
    s_barrier
    s_add_u32 m0, s35, 81536
    s_nop 0
    buffer_load_dwordx4 v10, s[12:15], 0 offen offset:384 lds
    s_add_u32 m0, s35, 90112
    s_mov_b32 s36, 172032
K2_hop7:
    s_cbranch_execz K2_hop8
    buffer_load_dwordx4 v12, s[8:11], s36 offen lds
    s_add_u32 m0, s35, 85632
    s_nop 0
    buffer_load_dwordx4 v11, s[12:15], 0 offen offset:384 lds
    s_add_u32 m0, s35, 94208
    s_nop 0
    buffer_load_dwordx4 v13, s[8:11], s36 offen lds
    s_waitcnt vmcnt(12)
    s_barrier
    s_add_u32 m0, s35, 97792
    s_nop 0
    buffer_load_dwordx4 v10, s[12:15], 0 offen offset:512 lds
    s_add_u32 m0, s35, 106496
    s_mov_b32 s36, 229376
    buffer_load_dwordx4 v12, s[8:11], s36 offen lds
    s_add_u32 m0, s35, 101888
    s_nop 0
    buffer_load_dwordx4 v11, s[12:15], 0 offen offset:512 lds
    s_add_u32 m0, s35, 110592
K2_hop8:
    s_cbranch_execz K2_hop9
    s_nop 0
    buffer_load_dwordx4 v13, s[8:11], s36 offen lds
    s_waitcnt vmcnt(12)
    s_barrier
    s_add_u32 m0, s35, 114048
    s_nop 0
    buffer_load_dwordx4 v10, s[12:15], 0 offen offset:640 lds
    s_add_u32 m0, s35, 122880
    s_mov_b32 s36, 286720
    buffer_load_dwordx4 v12, s[8:11], s36 offen lds
    s_add_u32 m0, s35, 118144
    s_nop 0
    buffer_load_dwordx4 v11, s[12:15], 0 offen offset:640 lds
    s_add_u32 m0, s35, 126976
    s_nop 0
    buffer_load_dwordx4 v13, s[8:11], s36 offen lds
    s_waitcnt vmcnt(12)
    s_barrier
    s_add_u32 m0, s35, 130304
K2_hop9:
    s_cbranch_execz K2_hop10
    s_nop 0
    buffer_load_dwordx4 v10, s[12:15], 0 offen offset:768 lds
    s_add_u32 m0, s35, 139264
    s_mov_b32 s36, 344064
    buffer_load_dwordx4 v12, s[8:11], s36 offen lds
    s_add_u32 m0, s35, 134400
    s_nop 0
    buffer_load_dwordx4 v11, s[12:15], 0 offen offset:768 lds
    s_add_u32 m0, s35, 143360
    s_nop 0
    buffer_load_dwordx4 v13, s[8:11], s36 offen lds
    s_waitcnt vmcnt(12)
    s_barrier
    s_waitcnt vmcnt(8)
    s_barrier
    s_waitcnt vmcnt(4)
    s_barrier
    s_waitcnt vmcnt(0)
    s_barrier
    s_endpgm
K2_comp:
    v_lshrrev_b32 v6, 1, v2
    v_xor_b32 v6, v3, v6
    v_lshlrev_b32 v6, 4, v6
K2_hop10:
    s_cbranch_execz K2_hop11
    v_lshl_add_u32 v22, v2, 7, v6
    v_xor_b32 v23, 64, v22
    v_add_u32 v24, 0x8000, v22
    v_add_u32 v25, 0x8000, v23
    v_add_u32 v26, 0x18000, v22
    v_add_u32 v27, 0x18000, v23
    v_bfe_u32 v6, v0, 2, 2
    v_lshl_add_u32 v7, v3, 3, v6
    v_lshlrev_b32 v7, 7, v7
    v_and_b32 v6, 2, v6
    v_and_b32 v13, 1, v3
    v_lshl_add_u32 v6, v13, 2, v6
    v_lshlrev_b32 v6, 4, v6
    v_and_b32 v13, 3, v0
    v_lshlrev_b32 v13, 3, v13
    s_lshl_b32 s31, s24, 5
    v_add_u32 v13, s31, v13
    v_xor_b32 v13, v13, v6
    v_add_u32 v13, v13, v7
    v_add_u32 v28, 0xa000, v13
    v_add_u32 v29, 0x1a000, v13
K2_hop11:
    s_cbranch_execz K2_end
    s_mov_b32 s43, 0x40400000
    s_mov_b32 s45, 0x40a00000
    s_mov_b32 s46, 0x40c00000
    s_mov_b32 s47, 0x40e00000
    s_mov_b32 s56, 0x41800000
    s_lshl_b32 s31, s28, 6
    s_lshl_b32 s32, s24, 4
    s_add_u32 s31, s31, s32
    v_add_u32 v6, s31, v2
    v_cvt_f32_u32 v7, v6
    v_mul_f32 v8, 0x3d924925, v7
    v_mul_f32 v7, 0x3b124925, v7
    v_lshlrev_b32 v13, 3, v3
    v_cvt_f32_u32 v13, v13
    v_cos_f32 v9, v8
    v_mul_f32 v13, v13, v7
    v_add_f32 v10, v13, v8
    v_add_f32 v9, v9, v9
    v_mov_b32 v92, v13
    v_fma_f32 v93, 1.0, v7, v13
    v_fma_f32 v94, 2.0, v7, v13
    v_fma_f32 v95, s43, v7, v13
K2_seg1:
K2_hop12:
    s_cbranch_execz K2_hop13
    v_fma_f32 v96, 4.0, v7, v13
    v_fma_f32 v97, s45, v7, v13
    v_fma_f32 v98, s46, v7, v13
    v_fma_f32 v99, s47, v7, v13
    v_sin_f32 v100, v92
    v_sin_f32 v101, v93
    v_sin_f32 v102, v94
    v_sin_f32 v103, v95
    v_sin_f32 v104, v96
    v_sin_f32 v105, v97
    v_sin_f32 v106, v98
    v_sin_f32 v107, v99
    v_cos_f32 v92, v92
    v_cos_f32 v93, v93
    v_cos_f32 v94, v94
    v_cos_f32 v95, v95
    v_cos_f32 v96, v96
    v_cos_f32 v97, v97
    v_cos_f32 v98, v98
    v_cos_f32 v99, v99
    v_mov_b32 v108, v10
    v_fma_f32 v109, 1.0, v7, v10
    v_fma_f32 v110, 2.0, v7, v10
    v_fma_f32 v111, s43, v7, v10
K2_hop13:
    s_cbranch_execz K2_hop14
    v_fma_f32 v112, 4.0, v7, v10
    v_fma_f32 v113, s45, v7, v10
    v_fma_f32 v114, s46, v7, v10
    v_fma_f32 v115, s47, v7, v10
    v_sin_f32 v116, v108
    v_sin_f32 v117, v109
    v_sin_f32 v118, v110
    v_sin_f32 v119, v111
    v_sin_f32 v120, v112
    v_sin_f32 v121, v113
    v_sin_f32 v122, v114
    v_sin_f32 v123, v115
    v_cos_f32 v108, v108
    v_cos_f32 v109, v109
    v_cos_f32 v110, v110
    v_cos_f32 v111, v111
    v_cos_f32 v112, v112
    v_cos_f32 v113, v113
    v_cos_f32 v114, v114
    v_cos_f32 v115, v115
    v_cvt_pk_bf16_f32 v32, v92, v93
    v_cvt_pk_bf16_f32 v64, v100, v101
    v_cvt_pk_bf16_f32 v33, v94, v95
K2_hop14:
    s_cbranch_execz K2_hop15
    v_cvt_pk_bf16_f32 v65, v102, v103
    v_cvt_pk_bf16_f32 v34, v96, v97
    v_cvt_pk_bf16_f32 v66, v104, v105
    v_cvt_pk_bf16_f32 v35, v98, v99
    v_cvt_pk_bf16_f32 v67, v106, v107
    v_cvt_pk_bf16_f32 v36, v108, v109
    v_cvt_pk_bf16_f32 v68, v116, v117
    v_cvt_pk_bf16_f32 v37, v110, v111
    v_cvt_pk_bf16_f32 v69, v118, v119
    v_cvt_pk_bf16_f32 v38, v112, v113
    v_cvt_pk_bf16_f32 v70, v120, v121
    v_cvt_pk_bf16_f32 v39, v114, v115
    v_cvt_pk_bf16_f32 v71, v122, v123
    s_waitcnt lgkmcnt(0)
    s_mov_b32 s4, s94
    s_mov_b32 s5, s95
    s_mov_b32 s6, 0x1c0000
K2_hop15:
    s_cbranch_execz K2_hop16
    s_mov_b32 s7, 0x20000
    s_add_u32 s20, s90, 0x300000
    s_addc_u32 s21, s91, 0
    s_mov_b32 s22, 0x2000
    s_mov_b32 s23, 0x20000
    v_lshlrev_b32 v11, 6, v2
    v_add_u32 v11, 0, v11
    v_add_u32 v11, s27, v11
    v_lshlrev_b32 v12, 2, v11
    buffer_load_dword v14, v12, s[20:23], 0 offen
    v_lshlrev_b32 v12, 3, v3
    s_lshl_b32 s31, s24, 5
    s_add_u32 s31, s31, s30
    v_add_u32 v12, s31, v12
    v_mad_u32_u24 v18, v11, s33, v12
    v_lshlrev_b32 v11, 6, v2
    v_add_u32 v11, 1024, v11
    v_add_u32 v11, s27, v11
    v_lshlrev_b32 v12, 2, v11
    buffer_load_dword v15, v12, s[20:23], 0 offen
    v_lshlrev_b32 v12, 3, v3
    s_lshl_b32 s31, s24, 5
    s_add_u32 s31, s31, s30
K2_hop16:
    s_cbranch_execz K2_hop17
    v_add_u32 v12, s31, v12
    v_mad_u32_u24 v19, v11, s33, v12
    v_lshlrev_b32 v11, 6, v2
    v_add_u32 v11, 0, v11
    v_add_u32 v11, s27, v11
    v_sub_u32 v11, 2048, v11
    v_lshlrev_b32 v12, 2, v11
    v_or_b32 v12, s34, v12
    buffer_load_dword v16, v12, s[20:23], 0 offen
    v_lshlrev_b32 v12, 3, v3
    s_lshl_b32 s31, s24, 5
    s_add_u32 s31, s31, s30
    v_add_u32 v12, s31, v12
    v_mad_u32_u24 v20, v11, s33, v12
    v_or_b32 v20, s34, v20
    v_lshlrev_b32 v11, 6, v2
    v_add_u32 v11, 1024, v11
    v_add_u32 v11, s27, v11
    v_sub_u32 v11, 2048, v11
    v_lshlrev_b32 v12, 2, v11
    v_or_b32 v12, s34, v12
    buffer_load_dword v17, v12, s[20:23], 0 offen
    v_lshlrev_b32 v12, 3, v3
    s_lshl_b32 s31, s24, 5
K2_hop17:
    s_cbranch_execz K2_hop18
    s_add_u32 s31, s31, s30
    v_add_u32 v12, s31, v12
    v_mad_u32_u24 v21, v11, s33, v12
    v_or_b32 v21, s34, v21
    v_and_b32 v11, 1, v3
    v_cmp_eq_u32 vcc, 1, v11
    v_lshlrev_b32 v11, 3, v11
    v_sub_u32 v12, v19, v11
    v_cndmask_b32 v18, v18, v12, vcc
    v_sub_u32 v12, v21, v11
    v_cndmask_b32 v20, v20, v12, vcc
    v_fma_f32 v92, v9, v108, -v92
    v_fma_f32 v93, v9, v109, -v93
    v_fma_f32 v94, v9, v110, -v94
    v_fma_f32 v95, v9, v111, -v95
    v_fma_f32 v96, v9, v112, -v96
    v_fma_f32 v97, v9, v113, -v97
    v_fma_f32 v98, v9, v114, -v98
    v_fma_f32 v99, v9, v115, -v99
    v_fma_f32 v100, v9, v116, -v100
    v_fma_f32 v101, v9, v117, -v101
K2_hop18:
    s_cbranch_execz K2_hop19
    v_fma_f32 v102, v9, v118, -v102
    v_fma_f32 v103, v9, v119, -v103
    v_fma_f32 v104, v9, v120, -v104
    v_fma_f32 v105, v9, v121, -v105
    v_fma_f32 v106, v9, v122, -v106
    v_fma_f32 v107, v9, v123, -v107
    v_cvt_pk_bf16_f32 v40, v92, v93
    v_cvt_pk_bf16_f32 v72, v100, v101
    v_cvt_pk_bf16_f32 v41, v94, v95
    v_cvt_pk_bf16_f32 v73, v102, v103
    v_cvt_pk_bf16_f32 v42, v96, v97
    v_cvt_pk_bf16_f32 v74, v104, v105
    v_cvt_pk_bf16_f32 v43, v98, v99
    v_cvt_pk_bf16_f32 v75, v106, v107
    v_fma_f32 v108, v9, v92, -v108
K2_hop19:
    s_cbranch_execz K2_hop20
    v_fma_f32 v109, v9, v93, -v109
    v_fma_f32 v110, v9, v94, -v110
    v_fma_f32 v111, v9, v95, -v111
    v_fma_f32 v112, v9, v96, -v112
    v_fma_f32 v113, v9, v97, -v113
    v_fma_f32 v114, v9, v98, -v114
    v_fma_f32 v115, v9, v99, -v115
    v_fma_f32 v116, v9, v100, -v116
    v_fma_f32 v117, v9, v101, -v117
    v_fma_f32 v118, v9, v102, -v118
    v_fma_f32 v119, v9, v103, -v119
    v_fma_f32 v120, v9, v104, -v120
    v_fma_f32 v121, v9, v105, -v121
    v_fma_f32 v122, v9, v106, -v122
    v_fma_f32 v123, v9, v107, -v123
    v_cvt_pk_bf16_f32 v44, v108, v109
K2_hop20:
    s_cbranch_execz K2_hop21
    v_cvt_pk_bf16_f32 v76, v116, v117
    v_cvt_pk_bf16_f32 v45, v110, v111
    v_cvt_pk_bf16_f32 v77, v118, v119
    v_cvt_pk_bf16_f32 v46, v112, v113
    v_cvt_pk_bf16_f32 v78, v120, v121
    v_cvt_pk_bf16_f32 v47, v114, v115
    v_cvt_pk_bf16_f32 v79, v122, v123
    v_fma_f32 v92, v9, v108, -v92
    v_fma_f32 v93, v9, v109, -v93
    v_fma_f32 v94, v9, v110, -v94
    v_fma_f32 v95, v9, v111, -v95
    v_fma_f32 v96, v9, v112, -v96
    v_fma_f32 v97, v9, v113, -v97
    v_fma_f32 v98, v9, v114, -v98
    v_fma_f32 v99, v9, v115, -v99
K2_hop21:
    s_cbranch_execz K2_hop22
    v_fma_f32 v100, v9, v116, -v100
    v_fma_f32 v101, v9, v117, -v101
    v_fma_f32 v102, v9, v118, -v102
    v_fma_f32 v103, v9, v119, -v103
    v_fma_f32 v104, v9, v120, -v104
    v_fma_f32 v105, v9, v121, -v105
    v_fma_f32 v106, v9, v122, -v106
    v_fma_f32 v107, v9, v123, -v107
    v_cvt_pk_bf16_f32 v48, v92, v93
    v_cvt_pk_bf16_f32 v80, v100, v101
    v_cvt_pk_bf16_f32 v49, v94, v95
    v_cvt_pk_bf16_f32 v81, v102, v103
    v_cvt_pk_bf16_f32 v50, v96, v97
    v_cvt_pk_bf16_f32 v82, v104, v105
    v_cvt_pk_bf16_f32 v51, v98, v99
    v_cvt_pk_bf16_f32 v83, v106, v107
K2_hop22:
    s_cbranch_execz K2_hop23
    v_fma_f32 v108, v9, v92, -v108
    v_fma_f32 v109, v9, v93, -v109
    v_fma_f32 v110, v9, v94, -v110
    v_fma_f32 v111, v9, v95, -v111
    v_fma_f32 v112, v9, v96, -v112
    v_fma_f32 v113, v9, v97, -v113
    v_fma_f32 v114, v9, v98, -v114
    v_fma_f32 v115, v9, v99, -v115
    v_fma_f32 v116, v9, v100, -v116
    v_fma_f32 v117, v9, v101, -v117
    v_fma_f32 v118, v9, v102, -v118
    v_fma_f32 v119, v9, v103, -v119
    v_fma_f32 v120, v9, v104, -v120
    v_fma_f32 v121, v9, v105, -v121
    v_fma_f32 v122, v9, v106, -v122
K2_hop23:
    s_cbranch_execz K2_hop24
    v_fma_f32 v123, v9, v107, -v123
    v_cvt_pk_bf16_f32 v52, v108, v109
    v_cvt_pk_bf16_f32 v84, v116, v117
    v_cvt_pk_bf16_f32 v53, v110, v111
    v_cvt_pk_bf16_f32 v85, v118, v119
    v_cvt_pk_bf16_f32 v54, v112, v113
    v_cvt_pk_bf16_f32 v86, v120, v121
    v_cvt_pk_bf16_f32 v55, v114, v115
    v_cvt_pk_bf16_f32 v87, v122, v123
    v_fma_f32 v92, v9, v108, -v92
    v_fma_f32 v93, v9, v109, -v93
    v_fma_f32 v94, v9, v110, -v94
    v_fma_f32 v95, v9, v111, -v95
    v_fma_f32 v96, v9, v112, -v96
    v_fma_f32 v97, v9, v113, -v97
    v_fma_f32 v98, v9, v114, -v98
K2_hop24:
    s_cbranch_execz K2_end
    v_fma_f32 v99, v9, v115, -v99
    v_fma_f32 v100, v9, v116, -v100
    v_fma_f32 v101, v9, v117, -v101
    v_fma_f32 v102, v9, v118, -v102
    v_fma_f32 v103, v9, v119, -v103
    v_fma_f32 v104, v9, v120, -v104
    v_fma_f32 v105, v9, v121, -v105
    v_fma_f32 v106, v9, v122, -v106
    v_fma_f32 v107, v9, v123, -v107
    v_cvt_pk_bf16_f32 v56, v92, v93
    v_cvt_pk_bf16_f32 v88, v100, v101
    v_cvt_pk_bf16_f32 v57, v94, v95
    v_cvt_pk_bf16_f32 v89, v102, v103
    v_cvt_pk_bf16_f32 v58, v96, v97
    v_cvt_pk_bf16_f32 v90, v104, v105
K2_seg2:
K2_hop25:
    s_cbranch_execz K2_hop26
    v_cvt_pk_bf16_f32 v59, v98, v99
    v_cvt_pk_bf16_f32 v91, v106, v107
    v_and_b32 v6, 1, v2
    v_lshlrev_b32 v6, 15, v6
    v_or_b32 v6, 0x3f00, v6
    v_cmp_eq_u32 vcc, 0, v3
    v_mov_b32 v61, 0
    v_mov_b32 v62, 0
    v_mov_b32 v63, 0
    v_cndmask_b32 v60, 0, v6, vcc
    v_lshlrev_b32 v6, 2, v3
    v_cvt_f32_u32 v6, v6
    v_lshl_add_u32 v7, v2, 1, s37
    v_cvt_f32_u32 v7, v7
    v_mul_f32 v7, 0x3c800000, v7
    v_mul_f32 v6, v6, v7
    v_fma_f32 v8, s56, v7, v6
    v_mov_b32 v148, v6
    v_fma_f32 v149, 1.0, v7, v6
    v_fma_f32 v150, 2.0, v7, v6
    v_fma_f32 v151, s43, v7, v6
    v_mov_b32 v152, v8
K2_hop26:
    s_cbranch_execz K2_hop27
    v_fma_f32 v153, 1.0, v7, v8
    v_fma_f32 v154, 2.0, v7, v8
    v_fma_f32 v155, s43, v7, v8
    v_sin_f32 v156, v148
    v_sin_f32 v157, v149
    v_sin_f32 v158, v150
    v_sin_f32 v159, v151
    v_sin_f32 v160, v152
    v_sin_f32 v161, v153
    v_sin_f32 v162, v154
    v_sin_f32 v163, v155
    v_cos_f32 v148, v148
    v_cos_f32 v149, v149
    v_cos_f32 v150, v150
    v_cos_f32 v151, v151
    v_cos_f32 v152, v152
    v_cos_f32 v153, v153
    v_cos_f32 v154, v154
    v_cos_f32 v155, v155
    v_cvt_pk_bf16_f32 v132, v156, v157
    v_cvt_pk_bf16_f32 v133, v158, v159
    v_cvt_pk_bf16_f32 v134, v160, v161
    v_cvt_pk_bf16_f32 v135, v162, v163
    v_cvt_pk_bf16_f32 v124, v148, v149
K2_hop27:
    s_cbranch_execz K2_hop28
    v_cvt_pk_bf16_f32 v125, v150, v151
    v_cvt_pk_bf16_f32 v126, v152, v153
    v_cvt_pk_bf16_f32 v127, v154, v155
    v_xor_b32 v136, 0x80000000, v132
    v_xor_b32 v140, 0x80008000, v132
    v_xor_b32 v144, 0x8000, v132
    v_xor_b32 v128, 0x80000000, v124
    v_xor_b32 v137, 0x80000000, v133
    v_xor_b32 v141, 0x80008000, v133
    v_xor_b32 v145, 0x8000, v133
    v_xor_b32 v129, 0x80000000, v125
    v_xor_b32 v138, 0x80000000, v134
    v_xor_b32 v142, 0x80008000, v134
    v_xor_b32 v146, 0x8000, v134
    v_xor_b32 v130, 0x80000000, v126
K2_hop28:
    s_cbranch_execz K2_hop29
    v_xor_b32 v139, 0x80000000, v135
    v_xor_b32 v143, 0x80008000, v135
    v_xor_b32 v147, 0x8000, v135
    v_xor_b32 v131, 0x80000000, v127
    s_barrier
    ds_read_b128 v[148:151], v22 offset:0
    ds_read_b128 v[152:155], v22 offset:2048
    ds_read_b128 v[156:159], v22 offset:4096
    ds_read_b128 v[160:163], v22 offset:6144
    ds_read_b128 v[164:167], v23 offset:0
    ds_read_b128 v[168:171], v23 offset:2048
    ds_read_b128 v[172:175], v23 offset:4096
    ds_read_b128 v[176:179], v23 offset:6144
    s_waitcnt lgkmcnt(7)
    v_mfma_f32_16x16x32_bf16 v[180:183], v[148:151], v[32:35], 0
    v_mfma_f32_16x16x32_bf16 v[196:199], v[148:151], v[64:67], 0
    s_waitcnt lgkmcnt(6)
K2_hop29:
    s_cbranch_execz K2_hop30
    v_mfma_f32_16x16x32_bf16 v[184:187], v[152:155], v[32:35], 0
    v_mfma_f32_16x16x32_bf16 v[200:203], v[152:155], v[64:67], 0
    s_waitcnt lgkmcnt(5)
    v_mfma_f32_16x16x32_bf16 v[188:191], v[156:159], v[32:35], 0
    v_mfma_f32_16x16x32_bf16 v[204:207], v[156:159], v[64:67], 0
    s_waitcnt lgkmcnt(4)
    v_mfma_f32_16x16x32_bf16 v[192:195], v[160:163], v[32:35], 0
    v_mfma_f32_16x16x32_bf16 v[208:211], v[160:163], v[64:67], 0
    ds_read_b128 v[148:151], v22 offset:8192
    ds_read_b128 v[152:155], v22 offset:10240
    ds_read_b128 v[156:159], v22 offset:12288
    ds_read_b128 v[160:163], v22 offset:14336
    s_waitcnt lgkmcnt(7)
    v_mfma_f32_16x16x32_bf16 v[180:183], v[164:167], v[36:39], v[180:183]
    v_mfma_f32_16x16x32_bf16 v[196:199], v[164:167], v[68:71], v[196:199]
    s_waitcnt lgkmcnt(6)
    v_mfma_f32_16x16x32_bf16 v[184:187], v[168:171], v[36:39], v[184:187]
    v_mfma_f32_16x16x32_bf16 v[200:203], v[168:171], v[68:71], v[200:203]
K2_hop30:
    s_cbranch_execz K2_hop31
    s_waitcnt lgkmcnt(5)
    v_mfma_f32_16x16x32_bf16 v[188:191], v[172:175], v[36:39], v[188:191]
    v_mfma_f32_16x16x32_bf16 v[204:207], v[172:175], v[68:71], v[204:207]
    s_waitcnt lgkmcnt(4)
    v_mfma_f32_16x16x32_bf16 v[192:195], v[176:179], v[36:39], v[192:195]
    v_mfma_f32_16x16x32_bf16 v[208:211], v[176:179], v[68:71], v[208:211]
    ds_read_b128 v[164:167], v23 offset:8192
    ds_read_b128 v[168:171], v23 offset:10240
    ds_read_b128 v[172:175], v23 offset:12288
    ds_read_b128 v[176:179], v23 offset:14336
    s_barrier
    s_waitcnt lgkmcnt(7)
    v_mfma_f32_16x16x32_bf16 v[180:183], v[148:151], v[40:43], v[180:183]
    ds_read_b64_tr_b16 v[228:229], v28 offset:0
    ds_read_b64_tr_b16 v[230:231], v28 offset:512
    v_mfma_f32_16x16x32_bf16 v[196:199], v[148:151], v[72:75], v[196:199]
    ds_read_b128 v[232:235], v24 offset:0
K2_hop31:
    s_cbranch_execz K2_hop32
    s_waitcnt lgkmcnt(9)
    v_mfma_f32_16x16x32_bf16 v[184:187], v[152:155], v[40:43], v[184:187]
    ds_read_b128 v[236:239], v24 offset:2048
    ds_read_b128 v[240:243], v24 offset:4096
    v_mfma_f32_16x16x32_bf16 v[200:203], v[152:155], v[72:75], v[200:203]
    ds_read_b128 v[244:247], v24 offset:6144
    s_waitcnt lgkmcnt(11)
    v_mfma_f32_16x16x32_bf16 v[188:191], v[156:159], v[40:43], v[188:191]
    ds_read_b64_tr_b16 v[92:93], v28 offset:4096
    ds_read_b64_tr_b16 v[94:95], v28 offset:4608
    v_mfma_f32_16x16x32_bf16 v[204:207], v[156:159], v[72:75], v[204:207]
    ds_read_b128 v[96:99], v25 offset:0
    s_waitcnt lgkmcnt(13)
    v_mfma_f32_16x16x32_bf16 v[192:195], v[160:163], v[40:43], v[192:195]
    ds_read_b128 v[100:103], v25 offset:2048
    ds_read_b128 v[104:107], v25 offset:4096
    v_mfma_f32_16x16x32_bf16 v[208:211], v[160:163], v[72:75], v[208:211]
K2_hop32:
    s_cbranch_execz K2_hop33
    ds_read_b128 v[108:111], v25 offset:6144
    ds_read_b128 v[148:151], v22 offset:16384
    ds_read_b128 v[152:155], v22 offset:18432
    ds_read_b128 v[156:159], v22 offset:20480
    ds_read_b128 v[160:163], v22 offset:22528
    s_barrier
    s_waitcnt lgkmcnt(15)
    v_mfma_f32_16x16x32_bf16 v[180:183], v[164:167], v[44:47], v[180:183]
    ds_read_b64_tr_b16 v[32:33], v28 offset:16384
    ds_read_b64_tr_b16 v[34:35], v28 offset:16896
    v_mfma_f32_16x16x32_bf16 v[196:199], v[164:167], v[76:79], v[196:199]
    ds_read_b128 v[36:39], v24 offset:16384
    v_mfma_f32_16x16x32_bf16 v[184:187], v[168:171], v[44:47], v[184:187]
    ds_read_b128 v[40:43], v24 offset:18432
    ds_read_b128 v[64:67], v24 offset:20480
    v_mfma_f32_16x16x32_bf16 v[200:203], v[168:171], v[76:79], v[200:203]
    ds_read_b128 v[68:71], v24 offset:22528
K2_hop33:
    s_cbranch_execz K2_hop34
    v_mfma_f32_16x16x32_bf16 v[188:191], v[172:175], v[44:47], v[188:191]
    ds_read_b64_tr_b16 v[72:73], v28 offset:20480
    ds_read_b64_tr_b16 v[74:75], v28 offset:20992
    v_mfma_f32_16x16x32_bf16 v[204:207], v[172:175], v[76:79], v[204:207]
    ds_read_b128 v[112:115], v25 offset:16384
    v_mfma_f32_16x16x32_bf16 v[192:195], v[176:179], v[44:47], v[192:195]
    ds_read_b128 v[116:119], v25 offset:18432
    ds_read_b128 v[120:123], v25 offset:20480
    v_mfma_f32_16x16x32_bf16 v[208:211], v[176:179], v[76:79], v[208:211]
    ds_read_b128 v[248:251], v25 offset:22528
    s_waitcnt lgkmcnt(15)
    v_mfma_f32_16x16x32_bf16 v[212:215], v[228:231], v[232:235], 0
    ds_read_b128 v[164:167], v23 offset:16384
    v_mfma_f32_16x16x32_bf16 v[216:219], v[228:231], v[236:239], 0
    v_mfma_f32_16x16x32_bf16 v[220:223], v[228:231], v[240:243], 0
    ds_read_b128 v[168:171], v23 offset:18432
K2_hop34:
    s_cbranch_execz K2_hop35
    v_mfma_f32_16x16x32_bf16 v[224:227], v[228:231], v[244:247], 0
    v_mfma_f32_16x16x32_bf16 v[212:215], v[92:95], v[96:99], v[212:215]
    ds_read_b128 v[172:175], v23 offset:20480
    v_mfma_f32_16x16x32_bf16 v[216:219], v[92:95], v[100:103], v[216:219]
    v_mfma_f32_16x16x32_bf16 v[220:223], v[92:95], v[104:107], v[220:223]
    ds_read_b128 v[176:179], v23 offset:22528
    v_mfma_f32_16x16x32_bf16 v[224:227], v[92:95], v[108:111], v[224:227]
    s_barrier
    v_mfma_f32_16x16x32_bf16 v[180:183], v[148:151], v[48:51], v[180:183]
    ds_read_b64_tr_b16 v[228:229], v28 offset:32768
    ds_read_b64_tr_b16 v[230:231], v28 offset:33280
    v_mfma_f32_16x16x32_bf16 v[196:199], v[148:151], v[80:83], v[196:199]
    ds_read_b128 v[232:235], v24 offset:32768
    s_waitcnt lgkmcnt(15)
    v_mfma_f32_16x16x32_bf16 v[184:187], v[152:155], v[48:51], v[184:187]
    ds_read_b128 v[236:239], v24 offset:34816
K2_hop35:
    s_cbranch_execz K2_hop36
    ds_read_b128 v[240:243], v24 offset:36864
    v_mfma_f32_16x16x32_bf16 v[200:203], v[152:155], v[80:83], v[200:203]
    ds_read_b128 v[244:247], v24 offset:38912
    v_mfma_f32_16x16x32_bf16 v[188:191], v[156:159], v[48:51], v[188:191]
    ds_read_b64_tr_b16 v[92:93], v28 offset:36864
    ds_read_b64_tr_b16 v[94:95], v28 offset:37376
    v_mfma_f32_16x16x32_bf16 v[204:207], v[156:159], v[80:83], v[204:207]
    ds_read_b128 v[96:99], v25 offset:32768
    v_mfma_f32_16x16x32_bf16 v[192:195], v[160:163], v[48:51], v[192:195]
    ds_read_b128 v[100:103], v25 offset:34816
    ds_read_b128 v[104:107], v25 offset:36864
    v_mfma_f32_16x16x32_bf16 v[208:211], v[160:163], v[80:83], v[208:211]
    ds_read_b128 v[108:111], v25 offset:38912
    v_mfma_f32_16x16x32_bf16 v[212:215], v[32:35], v[36:39], v[212:215]
    ds_read_b128 v[148:151], v22 offset:24576
    v_mfma_f32_16x16x32_bf16 v[216:219], v[32:35], v[40:43], v[216:219]
K2_hop36:
    s_cbranch_execz K2_end
    s_waitcnt lgkmcnt(15)
    v_mfma_f32_16x16x32_bf16 v[220:223], v[32:35], v[64:67], v[220:223]
    ds_read_b128 v[152:155], v22 offset:26624
    v_mfma_f32_16x16x32_bf16 v[224:227], v[32:35], v[68:71], v[224:227]
    v_mfma_f32_16x16x32_bf16 v[212:215], v[72:75], v[112:115], v[212:215]
    ds_read_b128 v[156:159], v22 offset:28672
    v_mfma_f32_16x16x32_bf16 v[216:219], v[72:75], v[116:119], v[216:219]
    v_mfma_f32_16x16x32_bf16 v[220:223], v[72:75], v[120:123], v[220:223]
    ds_read_b128 v[160:163], v22 offset:30720
    v_mfma_f32_16x16x32_bf16 v[224:227], v[72:75], v[248:251], v[224:227]
    s_barrier
    v_mfma_f32_16x16x32_bf16 v[180:183], v[164:167], v[52:55], v[180:183]
    ds_read_b64_tr_b16 v[32:33], v28 offset:49152
    ds_read_b64_tr_b16 v[34:35], v28 offset:49664
    v_mfma_f32_16x16x32_bf16 v[196:199], v[164:167], v[84:87], v[196:199]
    ds_read_b128 v[36:39], v24 offset:49152
K2_seg3:
K2_hop37:
    s_cbranch_execz K2_hop38
    v_mfma_f32_16x16x32_bf16 v[184:187], v[168:171], v[52:55], v[184:187]
    ds_read_b128 v[40:43], v24 offset:51200
    ds_read_b128 v[64:67], v24 offset:53248
    v_mfma_f32_16x16x32_bf16 v[200:203], v[168:171], v[84:87], v[200:203]
    ds_read_b128 v[68:71], v24 offset:55296
    s_waitcnt lgkmcnt(15)
    v_mfma_f32_16x16x32_bf16 v[188:191], v[172:175], v[52:55], v[188:191]
    ds_read_b64_tr_b16 v[72:73], v28 offset:53248
    ds_read_b64_tr_b16 v[74:75], v28 offset:53760
    v_mfma_f32_16x16x32_bf16 v[204:207], v[172:175], v[84:87], v[204:207]
    ds_read_b128 v[112:115], v25 offset:49152
    v_mfma_f32_16x16x32_bf16 v[192:195], v[176:179], v[52:55], v[192:195]
    ds_read_b128 v[116:119], v25 offset:51200
    ds_read_b128 v[120:123], v25 offset:53248
    v_mfma_f32_16x16x32_bf16 v[208:211], v[176:179], v[84:87], v[208:211]
    ds_read_b128 v[248:251], v25 offset:55296
K2_hop38:
    s_cbranch_execz K2_hop39
    v_mfma_f32_16x16x32_bf16 v[212:215], v[228:231], v[232:235], v[212:215]
    ds_read_b128 v[164:167], v23 offset:24576
    v_mfma_f32_16x16x32_bf16 v[216:219], v[228:231], v[236:239], v[216:219]
    v_mfma_f32_16x16x32_bf16 v[220:223], v[228:231], v[240:243], v[220:223]
    ds_read_b128 v[168:171], v23 offset:26624
    v_mfma_f32_16x16x32_bf16 v[224:227], v[228:231], v[244:247], v[224:227]
    s_waitcnt lgkmcnt(15)
    v_mfma_f32_16x16x32_bf16 v[212:215], v[92:95], v[96:99], v[212:215]
    ds_read_b128 v[172:175], v23 offset:28672
    v_mfma_f32_16x16x32_bf16 v[216:219], v[92:95], v[100:103], v[216:219]
    v_mfma_f32_16x16x32_bf16 v[220:223], v[92:95], v[104:107], v[220:223]
    ds_read_b128 v[176:179], v23 offset:30720
    v_mfma_f32_16x16x32_bf16 v[224:227], v[92:95], v[108:111], v[224:227]
    s_barrier
    v_mfma_f32_16x16x32_bf16 v[180:183], v[148:151], v[56:59], v[180:183]
    ds_read_b64_tr_b16 v[228:229], v29 offset:0
    ds_read_b64_tr_b16 v[230:231], v29 offset:512
K2_hop39:
    s_cbranch_execz K2_hop40
    v_mfma_f32_16x16x32_bf16 v[196:199], v[148:151], v[88:91], v[196:199]
    ds_read_b128 v[232:235], v26 offset:0
    v_mfma_f32_16x16x32_bf16 v[184:187], v[152:155], v[56:59], v[184:187]
    ds_read_b128 v[236:239], v26 offset:2048
    ds_read_b128 v[240:243], v26 offset:4096
    v_mfma_f32_16x16x32_bf16 v[200:203], v[152:155], v[88:91], v[200:203]
    ds_read_b128 v[244:247], v26 offset:6144
    v_mfma_f32_16x16x32_bf16 v[188:191], v[156:159], v[56:59], v[188:191]
    ds_read_b64_tr_b16 v[92:93], v29 offset:4096
    ds_read_b64_tr_b16 v[94:95], v29 offset:4608
    v_mfma_f32_16x16x32_bf16 v[204:207], v[156:159], v[88:91], v[204:207]
    ds_read_b128 v[96:99], v27 offset:0
    s_waitcnt lgkmcnt(15)
    v_mfma_f32_16x16x32_bf16 v[192:195], v[160:163], v[56:59], v[192:195]
    ds_read_b128 v[100:103], v27 offset:2048
    ds_read_b128 v[104:107], v27 offset:4096
K2_hop40:
    s_cbranch_execz K2_hop41
    v_mfma_f32_16x16x32_bf16 v[208:211], v[160:163], v[88:91], v[208:211]
    ds_read_b128 v[108:111], v27 offset:6144
    v_mfma_f32_16x16x32_bf16 v[212:215], v[32:35], v[36:39], v[212:215]
    v_mfma_f32_16x16x32_bf16 v[216:219], v[32:35], v[40:43], v[216:219]
    v_mfma_f32_16x16x32_bf16 v[220:223], v[32:35], v[64:67], v[220:223]
    v_mfma_f32_16x16x32_bf16 v[224:227], v[32:35], v[68:71], v[224:227]
    v_mfma_f32_16x16x32_bf16 v[212:215], v[72:75], v[112:115], v[212:215]
    v_mfma_f32_16x16x32_bf16 v[216:219], v[72:75], v[116:119], v[216:219]
    s_waitcnt lgkmcnt(15)
    v_mfma_f32_16x16x32_bf16 v[220:223], v[72:75], v[120:123], v[220:223]
    v_mfma_f32_16x16x32_bf16 v[224:227], v[72:75], v[248:251], v[224:227]
    s_barrier
    v_mfma_f32_16x16x32_bf16 v[180:183], v[164:167], v[60:63], v[180:183]
    ds_read_b64_tr_b16 v[32:33], v29 offset:16384
    ds_read_b64_tr_b16 v[34:35], v29 offset:16896
    s_waitcnt lgkmcnt(15)
    v_mfma_f32_16x16x32_bf16 v[184:187], v[168:171], v[60:63], v[184:187]
K2_hop41:
    s_cbranch_execz K2_hop42
    ds_read_b128 v[36:39], v26 offset:16384
    v_mfma_f32_16x16x32_bf16 v[188:191], v[172:175], v[60:63], v[188:191]
    ds_read_b128 v[40:43], v26 offset:18432
    ds_read_b128 v[64:67], v26 offset:20480
    s_waitcnt lgkmcnt(15)
    v_mfma_f32_16x16x32_bf16 v[192:195], v[176:179], v[60:63], v[192:195]
    ds_read_b128 v[68:71], v26 offset:22528
    s_waitcnt lgkmcnt(15)
    v_mfma_f32_16x16x32_bf16 v[212:215], v[228:231], v[232:235], v[212:215]
    ds_read_b64_tr_b16 v[72:73], v29 offset:20480
    ds_read_b64_tr_b16 v[74:75], v29 offset:20992
    s_waitcnt lgkmcnt(15)
    v_mfma_f32_16x16x32_bf16 v[216:219], v[228:231], v[236:239], v[216:219]
    ds_read_b128 v[112:115], v27 offset:16384
    v_mfma_f32_16x16x32_bf16 v[220:223], v[228:231], v[240:243], v[220:223]
    ds_read_b128 v[116:119], v27 offset:18432
    ds_read_b128 v[120:123], v27 offset:20480
K2_hop42:
    s_cbranch_execz K2_hop43
    s_waitcnt lgkmcnt(15)
    v_mfma_f32_16x16x32_bf16 v[224:227], v[228:231], v[244:247], v[224:227]
    ds_read_b128 v[248:251], v27 offset:22528
    s_waitcnt lgkmcnt(15)
    v_mfma_f32_16x16x32_bf16 v[212:215], v[92:95], v[96:99], v[212:215]
    v_cvt_pk_bf16_f32 v156, v196, v197
    v_cvt_pk_bf16_f32 v157, v198, v199
    s_waitcnt lgkmcnt(14)
    v_mfma_f32_16x16x32_bf16 v[216:219], v[92:95], v[100:103], v[216:219]
    v_cvt_pk_bf16_f32 v158, v200, v201
    v_cvt_pk_bf16_f32 v159, v202, v203
    s_waitcnt lgkmcnt(13)
    v_mfma_f32_16x16x32_bf16 v[220:223], v[92:95], v[104:107], v[220:223]
    v_cvt_pk_bf16_f32 v160, v204, v205
    v_cvt_pk_bf16_f32 v161, v206, v207
    s_waitcnt lgkmcnt(12)
    v_mfma_f32_16x16x32_bf16 v[224:227], v[92:95], v[108:111], v[224:227]
    v_cvt_pk_bf16_f32 v162, v208, v209
K2_hop43:
    s_cbranch_execz K2_hop44
    v_cvt_pk_bf16_f32 v163, v210, v211
    v_cvt_pk_bf16_f32 v148, v180, v181
    v_cvt_pk_bf16_f32 v149, v182, v183
    v_cvt_pk_bf16_f32 v150, v184, v185
    v_cvt_pk_bf16_f32 v151, v186, v187
    v_cvt_pk_bf16_f32 v152, v188, v189
    v_cvt_pk_bf16_f32 v153, v190, v191
    v_cvt_pk_bf16_f32 v154, v192, v193
    v_cvt_pk_bf16_f32 v155, v194, v195
    s_waitcnt vmcnt(0)
    v_mfma_f32_16x16x32_bf16 v[164:167], v[148:151], v[124:127], 0
    v_lshlrev_b32 v196, 16, v14
    v_mfma_f32_16x16x32_bf16 v[168:171], v[160:163], v[124:127], 0
    v_and_b32 v197, 0xffff0000, v14
    v_mfma_f32_16x16x32_bf16 v[172:175], v[148:151], v[128:131], 0
    v_lshlrev_b32 v198, 16, v15
    v_mfma_f32_16x16x32_bf16 v[176:179], v[160:163], v[128:131], 0
K2_hop44:
    s_cbranch_execz K2_hop45
    v_and_b32 v199, 0xffff0000, v15
    v_mfma_f32_16x16x32_bf16 v[164:167], v[152:155], v[132:135], v[164:167]
    v_lshlrev_b32 v200, 16, v16
    v_mfma_f32_16x16x32_bf16 v[168:171], v[156:159], v[140:143], v[168:171]
    v_and_b32 v201, 0xffff0000, v16
    v_mfma_f32_16x16x32_bf16 v[172:175], v[152:155], v[136:139], v[172:175]
    v_lshlrev_b32 v202, 16, v17
    v_mfma_f32_16x16x32_bf16 v[176:179], v[156:159], v[144:147], v[176:179]
    v_and_b32 v203, 0xffff0000, v17
    s_barrier
    s_waitcnt lgkmcnt(9)
    v_mfma_f32_16x16x32_bf16 v[212:215], v[32:35], v[36:39], v[212:215]
    ds_read_b64_tr_b16 v[228:229], v29 offset:32768
    ds_read_b64_tr_b16 v[230:231], v29 offset:33280
    v_add_f32 v180, v164, v168
    v_add_f32 v181, v165, v169
    s_waitcnt lgkmcnt(10)
    v_mfma_f32_16x16x32_bf16 v[216:219], v[32:35], v[40:43], v[216:219]
    ds_read_b128 v[232:235], v26 offset:32768
K2_hop45:
    s_cbranch_execz K2_hop46
    v_add_f32 v182, v166, v170
    v_add_f32 v183, v167, v171
    s_waitcnt lgkmcnt(10)
    v_mfma_f32_16x16x32_bf16 v[220:223], v[32:35], v[64:67], v[220:223]
    ds_read_b128 v[236:239], v26 offset:34816
    ds_read_b128 v[240:243], v26 offset:36864
    v_mul_f32 v180, v180, v196
    v_mul_f32 v181, v181, v196
    s_waitcnt lgkmcnt(11)
    v_mfma_f32_16x16x32_bf16 v[224:227], v[32:35], v[68:71], v[224:227]
    ds_read_b128 v[244:247], v26 offset:38912
    v_mul_f32 v182, v182, v196
    v_mul_f32 v183, v183, v196
    s_waitcnt lgkmcnt(9)
    v_mfma_f32_16x16x32_bf16 v[212:215], v[72:75], v[112:115], v[212:215]
    ds_read_b64_tr_b16 v[92:93], v29 offset:36864
    ds_read_b64_tr_b16 v[94:95], v29 offset:37376
    v_add_f32 v184, v172, v176
    v_add_f32 v185, v173, v177
    s_waitcnt lgkmcnt(10)
    v_mfma_f32_16x16x32_bf16 v[216:219], v[72:75], v[116:119], v[216:219]
K2_hop46:
    s_cbranch_execz K2_hop47
    ds_read_b128 v[96:99], v27 offset:32768
    v_add_f32 v186, v174, v178
    v_add_f32 v187, v175, v179
    s_waitcnt lgkmcnt(10)
    v_mfma_f32_16x16x32_bf16 v[220:223], v[72:75], v[120:123], v[220:223]
    ds_read_b128 v[100:103], v27 offset:34816
    ds_read_b128 v[104:107], v27 offset:36864
    v_mul_f32 v184, v184, v198
    v_mul_f32 v185, v185, v198
    s_waitcnt lgkmcnt(11)
    v_mfma_f32_16x16x32_bf16 v[224:227], v[72:75], v[248:251], v[224:227]
    ds_read_b128 v[108:111], v27 offset:38912
    v_mul_f32 v186, v186, v198
    v_mul_f32 v187, v187, v198
    s_waitcnt lgkmcnt(9)
    v_mfma_f32_16x16x32_bf16 v[212:215], v[228:231], v[232:235], v[212:215]
    v_sub_f32 v188, v164, v168
    v_sub_f32 v189, v165, v169
    s_waitcnt lgkmcnt(8)
    v_mfma_f32_16x16x32_bf16 v[216:219], v[228:231], v[236:239], v[216:219]
    v_sub_f32 v190, v166, v170
    v_sub_f32 v191, v167, v171
    s_waitcnt lgkmcnt(7)
K2_hop47:
    s_cbranch_execz K2_hop48
    v_mfma_f32_16x16x32_bf16 v[220:223], v[228:231], v[240:243], v[220:223]
    v_mul_f32 v188, v188, v200
    v_mul_f32 v189, v189, v200
    s_waitcnt lgkmcnt(6)
    v_mfma_f32_16x16x32_bf16 v[224:227], v[228:231], v[244:247], v[224:227]
    v_mul_f32 v190, v190, v200
    v_mul_f32 v191, v191, v200
    s_waitcnt lgkmcnt(3)
    v_mfma_f32_16x16x32_bf16 v[212:215], v[92:95], v[96:99], v[212:215]
    v_sub_f32 v192, v172, v176
    v_sub_f32 v193, v173, v177
    s_waitcnt lgkmcnt(2)
    v_mfma_f32_16x16x32_bf16 v[216:219], v[92:95], v[100:103], v[216:219]
    v_sub_f32 v194, v174, v178
    v_sub_f32 v195, v175, v179
    s_waitcnt lgkmcnt(1)
    v_mfma_f32_16x16x32_bf16 v[220:223], v[92:95], v[104:107], v[220:223]
    v_mul_f32 v192, v192, v202
    v_mul_f32 v193, v193, v202
    s_waitcnt lgkmcnt(0)
    v_mfma_f32_16x16x32_bf16 v[224:227], v[92:95], v[108:111], v[224:227]
    v_mul_f32 v194, v194, v202
    v_mul_f32 v195, v195, v202
    v_fmac_f32 v180, v212, v197
    v_fmac_f32 v181, v213, v197
K2_hop48:
    s_cbranch_execz K2_hop49
    v_fmac_f32 v182, v214, v197
    v_fmac_f32 v183, v215, v197
    v_cvt_pk_bf16_f32 v204, v180, v181
    v_cvt_pk_bf16_f32 v205, v182, v183
    v_fmac_f32 v184, v216, v199
    v_fmac_f32 v185, v217, v199
    v_fmac_f32 v186, v218, v199
    v_fmac_f32 v187, v219, v199
    v_cvt_pk_bf16_f32 v206, v184, v185
    v_cvt_pk_bf16_f32 v207, v186, v187
    s_nop 0
    v_permlane16_swap_b32 v204, v206
    v_permlane16_swap_b32 v205, v207
    buffer_store_dwordx4 v[204:207], v18, s[4:7], 0 offen
    v_fmac_f32 v188, v220, v201
    v_fmac_f32 v189, v221, v201
    v_fmac_f32 v190, v222, v201
    v_fmac_f32 v191, v223, v201
    v_cvt_pk_bf16_f32 v208, v188, v189
    v_cvt_pk_bf16_f32 v209, v190, v191
    v_fmac_f32 v192, v224, v203
    v_fmac_f32 v193, v225, v203
    v_fmac_f32 v194, v226, v203
    v_fmac_f32 v195, v227, v203
K2_hop49:
    s_cbranch_execz K2_end
    v_cvt_pk_bf16_f32 v210, v192, v193
    v_cvt_pk_bf16_f32 v211, v194, v195
    s_nop 0
    v_permlane16_swap_b32 v208, v210
    v_permlane16_swap_b32 v209, v211
    buffer_store_dwordx4 v[208:211], v20, s[4:7], 0 offen
K2_end:
    s_endpgm
.section .rodata,"a"
.p2align 6
.amdhsa_kernel fnet_k1_kernel
  .amdhsa_next_free_vgpr 232
  .amdhsa_next_free_sgpr 102
  .amdhsa_accum_offset 232
  .amdhsa_group_segment_fixed_size 0
  .amdhsa_kernarg_size 96
  .amdhsa_user_sgpr_count 2
  .amdhsa_user_sgpr_kernarg_segment_ptr 1
  .amdhsa_system_sgpr_workgroup_id_x 1
.end_amdhsa_kernel
.p2align 6
.amdhsa_kernel fnet_k2_kernel
  .amdhsa_next_free_vgpr 256
  .amdhsa_next_free_sgpr 102
  .amdhsa_accum_offset 256
  .amdhsa_group_segment_fixed_size 0
  .amdhsa_kernarg_size 96
  .amdhsa_user_sgpr_count 2
  .amdhsa_user_sgpr_kernarg_segment_ptr 1
  .amdhsa_system_sgpr_workgroup_id_x 1
.end_amdhsa_kernel
```
